```python
import torch

def _softmax(x, axis=-1):
    return torch.softmax(x, dim=axis)

def _gelu(x):
    return torch.nn.functional.gelu(x, approximate='tanh')

def _silu(x):
    return torch.nn.functional.silu(x)

def _sigmoid(x):
    return torch.sigmoid(x)

def _layernorm(x, axis=-1, eps=1e-05):
    m = x.mean(dim=axis, keepdim=True)
    v = x.var(dim=axis, keepdim=True, unbiased=False)
    return (x - m) / torch.sqrt(v + eps)

def _scatter_add(tgt, idx, src, axis=0):
    return tgt.clone().index_add_(axis, idx, src)

def _segment_sum(src, seg, n):
    out = torch.zeros((n,) + src.shape[1:], dtype=src.dtype)
    return out.index_add_(0, seg, src)

def _pad(x, pw):
    flat = tuple((v for pair in reversed(pw) for v in pair))
    return torch.nn.functional.pad(x, flat)
kernel_name = 'adaLN_cond__compressed_kv_cla__dense_activation_relu__decode'

def setup_inputs():

    _w = lambda a: (lambda t: t.to(torch.bfloat16) if t.is_floating_point() else t)(torch.as_tensor(a))

    def _A_setup():
        B, H, Sq, Sk, D, M = (1, 32, 1, 8192, 192, 640)
        Dc = 4 * D
        return {'x': _w((lambda *s: torch.randn(*s, dtype=torch.bfloat16) * 0.1)(B, Sq, M)), 'c_kv': _w((lambda *s: torch.randn(*s, dtype=torch.bfloat16) * 3.2)(B, Sk, Dc)), 'w_q': _w((lambda *s: torch.randn(*s, dtype=torch.bfloat16) * 1.6)(M, H, D) * M ** (-0.5)), 'w_uk': _w((lambda *s: torch.randn(*s, dtype=torch.bfloat16) * 1.6)(Dc, H, D) * Dc ** (-0.5)), 'w_uv': _w((lambda *s: torch.randn(*s, dtype=torch.bfloat16) * 3.2)(Dc, H, D) * Dc ** (-0.5)), 'w_o': _w((lambda *s: torch.randn(*s, dtype=torch.bfloat16) * 3.2)(H, D, M) * (H * D) ** (-0.5))}
    _A_in = _A_setup()

    def _B_setup():
        B, S, D, Dff = (1, 1, 640, 1536)
        return {'x': _w((lambda *s: torch.randn(*s, dtype=torch.bfloat16) * 0.1)(B, S, D)), 'w1': _w((lambda *s: torch.randn(*s, dtype=torch.bfloat16) * 0.1)(D, Dff)), 'w2': _w((lambda *s: torch.randn(*s, dtype=torch.bfloat16) * 0.1)(Dff, D))}
    _B_in = _B_setup()
    return {'A_x': _A_in['x'], 'A_c_kv': _A_in['c_kv'], 'A_w_q': _A_in['w_q'], 'A_w_uk': _A_in['w_uk'], 'A_w_uv': _A_in['w_uv'], 'A_w_o': _A_in['w_o'], 'B_x': _B_in['x'], 'B_w1': _B_in['w1'], 'B_w2': _B_in['w2'], 'c': _w((lambda *s: torch.randn(*s, dtype=torch.bfloat16) * 0.8)(1, 640) * 8.0), 'w_mod': _w((lambda *s: torch.randn(*s, dtype=torch.bfloat16) * 0.8)(640, 6 * 640) * 640 ** (-0.5) * 8.0)}

def reference(A_x, A_c_kv, A_w_q, A_w_uk, A_w_uv, A_w_o, B_x, B_w1, B_w2, c, w_mod):

    def _A_ref(x, c_kv, w_q, w_uk, w_uv, w_o):
        B, Sq, M = (x.shape[0], x.shape[1], x.shape[2])
        Sk = c_kv.shape[1]
        H, D = (w_q.shape[1], w_q.shape[2])
        q = torch.einsum('bqm,mhd->bhqd', x, w_q)
        k = torch.einsum('bkc,chd->bhkd', c_kv, w_uk)
        v = torch.einsum('bkc,chd->bhkd', c_kv, w_uv)
        scores = torch.einsum('bhqd,bhkd->bhqk', q, k) * D ** (-0.5)
        off = Sk - Sq
        qi = torch.arange(Sq)[:, None]
        kj = torch.arange(Sk)[None, :]
        cmask = kj <= qi + off
        scores = torch.where(cmask[None, None], scores, -1000000000.0)
        p = _softmax(scores, axis=-1)
        ctx = torch.einsum('bhqk,bhkd->bhqd', p, v)
        return torch.einsum('bhqd,hdm->bqm', ctx, w_o)

    def _B_ref(x, w1, w2):
        h = torch.einsum('bsd,df->bsf', x, w1)
        zero = torch.zeros_like(h)
        h = torch.maximum(h, zero)
        return torch.einsum('bsf,fd->bsd', h, w2)
    x = A_x
    mod = (_silu(c) @ w_mod).reshape(c.shape[0], 6, 1, -1)
    sa, ca, ga, sb, cb, gb = (mod[:, 0].clone(), mod[:, 1].clone(), mod[:, 2].clone(), mod[:, 3].clone(), mod[:, 4].clone(), mod[:, 5].clone())
    h = _layernorm(x, axis=-1) * (1 + ca) + sa
    x = x + ga * _A_ref(h, A_c_kv, A_w_q, A_w_uk, A_w_uv, A_w_o)
    h = _layernorm(x, axis=-1) * (1 + cb) + sb
    x = x + gb * _B_ref(h, B_w1, B_w2)
    return x
```

```asm
; @launch grid=(256,1,1) block=(512,1,1) lds=160000
.amdgcn_target "amdgcn-amd-amdhsa--gfx950"
.text
.globl adaLN_cond__compressed_kv_cla__dense_activation_relu__decode_kernel
.p2align 8
.type adaLN_cond__compressed_kv_cla__dense_activation_relu__decode_kernel,@function
.set CODE_LAST, 0x854c
adaLN_cond__compressed_kv_cla__dense_activation_relu__decode_kernel:
    s_cmp_ge_u32 s2, 256
    s_cbranch_scc1 Lend
    s_load_dwordx16 s[4:19], s[0:1], 0
    s_nop 0
    s_load_dwordx8 s[20:27], s[0:1], 64
    s_load_dwordx4 s[28:31], s[0:1], 96
    s_getpc_b64 s[36:37]
Lpc:
    v_lshrrev_b32 v4, 6, v0
    v_and_b32 v1, 63, v0
    v_readfirstlane_b32 s3, v4
    v_and_b32 v2, 15, v0
    v_lshrrev_b32 v3, 4, v1
    s_cmp_lt_u32 s2, 128
    s_cbranch_scc1 LB
    s_and_b32 s44, s2, 7
    s_lshl_b32 s44, s44, 4
    s_bfe_u32 s40, s2, 0x40003
    s_add_u32 s44, s44, s40
    s_xor_b32 s43, s44, 0
    s_cmp_lt_u32 s44, 64
    s_cselect_b32 s43, s44, s43
    s_mul_i32 s39, s43, 205
    s_lshr_b32 s39, s39, 11
    s_mul_i32 s40, s39, 10
    s_sub_u32 s38, s43, s40
    s_lshr_b32 s47, s44, 2
    s_and_b32 s41, s44, 3
    v_mov_b32 v12, 0
    s_mul_i32 s40, s39, 80
    s_lshl_b32 s42, s3, 4
    s_add_u32 s40, s40, s42
    v_lshl_add_u32 v5, v3, 2, s40
    v_mul_u32_u24 v4, 7680, v5
    v_lshrrev_b32 v6, 3, v2
    v_mul_u32_u24 v6, 1152, v6
    v_lshl_add_u32 v6, v2, 4, v6
    s_lshl_b32 s42, s38, 7
    v_add3_u32 v4, v4, v6, s42
    v_lshlrev_b32 v5, 1, v5
    s_waitcnt lgkmcnt(0)
    s_cmp_lt_u32 s3, 5
    s_cbranch_scc0 LA_nos1
    s_cmp_lt_u32 s39, 8
    s_cbranch_scc0 LA_nos1
    global_load_dwordx2 v[32:33], v5, s[22:23]
    global_load_dwordx4 v[16:19], v4, s[24:25] offset:0 nt
    v_add_u32 v4, 7680, v4
    global_load_dwordx4 v[20:23], v4, s[24:25] offset:0 nt
    v_add_u32 v4, 7680, v4
    global_load_dwordx4 v[24:27], v4, s[24:25] offset:0 nt
    v_add_u32 v4, 7680, v4
    global_load_dwordx4 v[28:31], v4, s[24:25] offset:0 nt
    global_load_dword v15, v12, s[30:31] sc1
    s_branch LA2
LB:
    s_and_b32 s39, s2, 7
    s_lshr_b32 s38, s2, 3
    s_mul_i32 s55, s38, 43
    s_lshr_b32 s55, s55, 7
    s_mul_i32 s40, s55, 3
    s_sub_u32 s40, s38, s40
    s_lshl_b32 s40, s40, 2
    s_mul_i32 s45, s39, 12
    s_add_u32 s45, s45, s40
    s_lshr_b32 s40, s3, 1
    s_add_u32 s45, s45, s40
    s_and_b32 s53, s3, 1
    s_lshl_b32 s42, s55, 1
    s_add_u32 s53, s53, s42
    v_mov_b32 v12, 0
    s_lshl_b32 s40, s53, 6
    s_lshl_b32 s41, s45, 7
    v_lshrrev_b32 v4, 3, v2
    v_lshlrev_b32 v4, 5, v4
    v_lshl_add_u32 v4, v3, 3, v4
    v_add_u32 v4, s40, v4
    v_mul_u32_u24 v4, 12288, v4
    v_and_b32 v5, 7, v2
    v_lshl_add_u32 v4, v5, 4, v4
    v_add_u32 v4, s41, v4
    v_lshlrev_b32 v6, 2, v1
    s_lshl_b32 s42, s3, 3
    v_and_b32 v7, 7, v1
    v_add_u32 v7, s42, v7
    v_lshrrev_b32 v8, 5, v1
    v_lshl_add_u32 v13, v8, 6, v7
    s_min_u32 s40, s55, 4
    s_lshl_b32 s40, s40, 7
    v_add_u32 v7, s40, v13
    v_lshlrev_b32 v7, 1, v7
    s_waitcnt lgkmcnt(0)
    global_load_dword v16, v6, s[4:5] offset:0
    global_load_dword v17, v6, s[4:5] offset:256
    global_load_dword v18, v6, s[4:5] offset:512
    global_load_dword v19, v6, s[4:5] offset:768
    global_load_dword v20, v6, s[4:5] offset:1024
    global_load_ushort v21, v7, s[4:5]
    s_cmp_lt_u32 s2, 120
    s_cbranch_scc0 LB_nowq
    global_load_dwordx4 v[64:67], v4, s[8:9] offset:0 nt
    v_add_u32 v4, 12288, v4
    global_load_dwordx4 v[68:71], v4, s[8:9] offset:0 nt
    v_add_u32 v4, 12288, v4
    global_load_dwordx4 v[72:75], v4, s[8:9] offset:0 nt
    v_add_u32 v4, 12288, v4
    global_load_dwordx4 v[76:79], v4, s[8:9] offset:0 nt
    v_add_u32 v4, 12288, v4
    global_load_dwordx4 v[80:83], v4, s[8:9] offset:0 nt
    v_add_u32 v4, 12288, v4
    global_load_dwordx4 v[84:87], v4, s[8:9] offset:0 nt
    v_add_u32 v4, 12288, v4
    global_load_dwordx4 v[88:91], v4, s[8:9] offset:0 nt
    v_add_u32 v4, 12288, v4
    global_load_dwordx4 v[92:95], v4, s[8:9] offset:0 nt
LB_nowq:
    global_load_dword v15, v12, s[30:31] sc1
    s_branch LB2
LA2:
    s_mov_b32 s34, 0x05040100
    s_mov_b32 s35, 0x07060302
    s_mov_b32 s33, 0
    s_mov_b32 s56, 0x3fb8aa3b
    s_mov_b32 s57, 0x32a57060
    s_mov_b32 s58, 0x3f317218
    s_mov_b32 s59, 0x3d93cd3a
    s_waitcnt vmcnt(5)
    v_lshlrev_b32 v36, 16, v32
    v_and_b32 v37, 0xffff0000, v32
    v_lshlrev_b32 v38, 16, v33
    v_and_b32 v39, 0xffff0000, v33
    v_mul_f32 v8, s56, v36
    v_fma_f32 v9, v36, s56, -v8
    v_fma_f32 v9, v36, s57, v9
    v_exp_f32 v8, -v8
    v_mul_f32 v9, s58, v9
    v_fma_f32 v8, -v8, v9, v8
    v_min_f32 v8, 0x7f000000, v8
    v_add_f32 v8, 1.0, v8
    v_rcp_f32 v9, v8
    s_nop 0
    v_fma_f32 v10, -v8, v9, 1.0
    v_fma_f32 v9, v10, v9, v9
    v_mul_f32 v11, v36, v9
    v_fma_f32 v10, -v8, v11, v36
    v_fma_f32 v11, v10, v9, v11
    v_cvt_pk_bf16_f32 v36, v11, v11
    v_and_b32 v36, 0xffff0000, v36
    v_mul_f32 v8, s56, v37
    v_fma_f32 v9, v37, s56, -v8
    v_fma_f32 v9, v37, s57, v9
    v_exp_f32 v8, -v8
    v_mul_f32 v9, s58, v9
    v_fma_f32 v8, -v8, v9, v8
    v_min_f32 v8, 0x7f000000, v8
    v_add_f32 v8, 1.0, v8
    v_rcp_f32 v9, v8
    s_nop 0
    v_fma_f32 v10, -v8, v9, 1.0
    v_fma_f32 v9, v10, v9, v9
    v_mul_f32 v11, v37, v9
    v_fma_f32 v10, -v8, v11, v37
    v_fma_f32 v11, v10, v9, v11
    v_cvt_pk_bf16_f32 v37, v11, v11
    v_and_b32 v37, 0xffff0000, v37
    v_mul_f32 v8, s56, v38
    v_fma_f32 v9, v38, s56, -v8
    v_fma_f32 v9, v38, s57, v9
    v_exp_f32 v8, -v8
    v_mul_f32 v9, s58, v9
    v_fma_f32 v8, -v8, v9, v8
    v_min_f32 v8, 0x7f000000, v8
    v_add_f32 v8, 1.0, v8
    v_rcp_f32 v9, v8
    s_nop 0
    v_fma_f32 v10, -v8, v9, 1.0
    v_fma_f32 v9, v10, v9, v9
    v_mul_f32 v11, v38, v9
    v_fma_f32 v10, -v8, v11, v38
    v_fma_f32 v11, v10, v9, v11
    v_cvt_pk_bf16_f32 v38, v11, v11
    v_and_b32 v38, 0xffff0000, v38
    v_mul_f32 v8, s56, v39
    v_fma_f32 v9, v39, s56, -v8
    v_fma_f32 v9, v39, s57, v9
    v_exp_f32 v8, -v8
    v_mul_f32 v9, s58, v9
    v_fma_f32 v8, -v8, v9, v8
    v_min_f32 v8, 0x7f000000, v8
    v_add_f32 v8, 1.0, v8
    v_rcp_f32 v9, v8
    s_nop 0
    v_fma_f32 v10, -v8, v9, 1.0
    v_fma_f32 v9, v10, v9, v9
    v_mul_f32 v11, v39, v9
    v_fma_f32 v10, -v8, v11, v39
    v_fma_f32 v11, v10, v9, v11
    v_cvt_pk_bf16_f32 v39, v11, v11
    v_and_b32 v39, 0xffff0000, v39
    v_perm_b32 v34, v37, v36, s35
    v_perm_b32 v35, v39, v38, s35
    v_cmp_eq_u32 vcc, 1, v3
    v_lshlrev_b32 v4, 5, v2
    v_lshl_add_u32 v4, v3, 4, v4
    s_lshl_b32 s40, s3, 9
    v_add_u32 v4, s40, v4
    s_waitcnt vmcnt(1)
    v_perm_b32 v40, v20, v16, s34
    v_perm_b32 v41, v28, v24, s34
    s_nop 1
    v_mfma_f32_16x16x16_bf16 v[64:67], v[34:35], v[40:41], 0
    v_perm_b32 v42, v20, v16, s35
    v_perm_b32 v43, v28, v24, s35
    s_nop 1
    v_mfma_f32_16x16x16_bf16 v[68:71], v[34:35], v[42:43], 0
    v_perm_b32 v44, v21, v17, s34
    v_perm_b32 v45, v29, v25, s34
    s_nop 1
    v_mfma_f32_16x16x16_bf16 v[72:75], v[34:35], v[44:45], 0
    v_perm_b32 v46, v21, v17, s35
    v_perm_b32 v47, v29, v25, s35
    s_nop 1
    v_mfma_f32_16x16x16_bf16 v[76:79], v[34:35], v[46:47], 0
    v_perm_b32 v48, v22, v18, s34
    v_perm_b32 v49, v30, v26, s34
    s_nop 1
    v_mfma_f32_16x16x16_bf16 v[80:83], v[34:35], v[48:49], 0
    v_perm_b32 v50, v22, v18, s35
    v_perm_b32 v51, v30, v26, s35
    s_nop 1
    v_mfma_f32_16x16x16_bf16 v[84:87], v[34:35], v[50:51], 0
    v_perm_b32 v52, v23, v19, s34
    v_perm_b32 v53, v31, v27, s34
    s_nop 1
    v_mfma_f32_16x16x16_bf16 v[88:91], v[34:35], v[52:53], 0
    v_perm_b32 v54, v23, v19, s35
    v_perm_b32 v55, v31, v27, s35
    s_nop 1
    v_mfma_f32_16x16x16_bf16 v[92:95], v[34:35], v[54:55], 0
    v_cndmask_b32 v8, v64, v80, vcc
    v_cndmask_b32 v9, v68, v84, vcc
    s_nop 0
    v_cndmask_b32 v10, v72, v88, vcc
    s_nop 3
    v_cndmask_b32 v11, v76, v92, vcc
    s_mov_b32 exec_lo, 0xffffffff
    s_mov_b32 exec_hi, 0x0
    ds_write_b128 v4, v[8:11]
    s_mov_b64 exec, -1
    s_waitcnt vmcnt(0)
    v_readfirstlane_b32 s32, v15
    s_mul_i32 s32, s32, 0x9E3779B1
    s_add_u32 s32, s32, 0x7F4A7C15
    s_branch LA_b1
LA_nos1:
    s_nop 0
    global_load_dword v15, v12, s[30:31] sc1
    s_cmp_lt_u32 s3, 6
    s_cbranch_scc0 LA_nos1b
LA_nos1b:
    s_mov_b32 s34, 0x05040100
    s_mov_b32 s35, 0x07060302
    s_mov_b32 s33, 0
    s_mov_b32 s56, 0x3fb8aa3b
    s_mov_b32 s57, 0x32a57060
    s_mov_b32 s58, 0x3f317218
    s_mov_b32 s59, 0x3d93cd3a
    s_cmp_eq_u32 s3, 7
    s_cbranch_scc0 LA_not7
    v_mov_b32 v8, -1
    v_mov_b32 v9, -1
    v_mov_b32 v10, -1
    v_mov_b32 v11, -1
    s_mul_i32 s40, s44, 384
    s_add_u32 s40, s40, 360448
    v_min_u32 v4, 23, v1
    v_lshl_add_u32 v4, v4, 4, s40
    global_store_dwordx4 v4, v[8:11], s[30:31] sc1
    s_getreg_b32 s51, hwreg(HW_REG_XCC_ID, 0, 4)
    s_waitcnt vmcnt(0)
    v_readfirstlane_b32 s32, v15
    s_mul_i32 s32, s32, 0x9E3779B1
    s_add_u32 s32, s32, 0x7F4A7C15
    s_lshl_b32 s40, s2, 4
    s_add_u32 s40, s40, 4096
    v_mov_b32 v4, s40
    v_mov_b32 v6, s32
    v_mov_b32 v7, s51
    s_mov_b32 exec_lo, 0x1
    s_mov_b32 exec_hi, 0x0
    global_store_dwordx2 v4, v[6:7], s[30:31] sc1
    s_mov_b64 exec, -1
    s_mul_i32 s40, s44, 3072
    s_add_u32 s40, s40, 557056
    v_lshl_add_u32 v4, v1, 4, s40
    global_store_dwordx4 v4, v[8:11], s[30:31] sc1
    global_store_dwordx4 v4, v[8:11], s[30:31] offset:1024 sc1
    global_store_dwordx4 v4, v[8:11], s[30:31] offset:2048 sc1
    s_lshl_b32 s40, s47, 13
    s_lshl_b32 s42, s41, 9
    s_add_u32 s40, s40, s42
    s_add_u32 s40, s40, 98304
    v_lshrrev_b32 v4, 5, v1
    v_lshlrev_b32 v4, 11, v4
    v_and_b32 v5, 31, v1
    v_lshl_add_u32 v4, v5, 4, v4
    v_add_u32 v4, s40, v4
    v_add_u32 v5, 4096, v4
    global_store_dwordx4 v4, v[8:11], s[30:31] sc1
    global_store_dwordx4 v5, v[8:11], s[30:31] sc1
    s_mul_i32 s40, s47, 3072
    s_lshl_b32 s42, s41, 8
    s_add_u32 s40, s40, s42
    s_add_u32 s40, s40, 950272
    v_min_u32 v4, 2, v3
    v_lshlrev_b32 v4, 10, v4
    v_lshl_add_u32 v4, v2, 4, v4
    v_add_u32 v4, s40, v4
    global_store_dwordx4 v4, v[8:11], s[30:31] sc1
    s_branch LA_b1
LA_not7:
    s_cmp_eq_u32 s3, 6
    s_cbranch_scc0 LA_b1
    s_lshr_b32 s50, s2, 3
    s_lshl_b32 s50, s50, 10
    v_lshlrev_b32 v4, 4, v1
    v_add_u32 v4, s50, v4
    v_min_u32 v4, CODE_LAST, v4
    global_load_dword v14, v4, s[36:37]
    v_add_u32 v4, 32768, v4
    v_min_u32 v4, CODE_LAST, v4
    global_load_dword v14, v4, s[36:37]
LA_b1:
    v_lshlrev_b32 v4, 2, v1
    s_lshl_b32 s40, s38, 13
    s_lshl_b32 s42, s39, 7
    s_add_u32 s40, s40, s42
    s_add_u32 s40, s40, 8192
    v_lshrrev_b32 v5, 3, v1
    v_lshlrev_b32 v5, 10, v5
    v_and_b32 v6, 7, v1
    v_lshl_add_u32 v5, v6, 4, v5
    v_add_u32 v5, s40, v5
    v_mov_b32 v9, s32
    v_mov_b32 v11, s32
    s_cmp_lt_u32 s39, 8
    s_cbranch_scc0 LA_u80
    s_waitcnt lgkmcnt(0)
    s_barrier
    s_cmp_eq_u32 s3, 0
    s_cbranch_scc0 LA_uk0
    ds_read2st64_b32 v[16:17], v4 offset0:0 offset1:1
    ds_read2st64_b32 v[18:19], v4 offset0:2 offset1:3
    ds_read2st64_b32 v[20:21], v4 offset0:4 offset1:5
    ds_read2st64_b32 v[22:23], v4 offset0:6 offset1:7
    ds_read2st64_b32 v[24:25], v4 offset0:8 offset1:9
    s_waitcnt lgkmcnt(0)
    v_add_f32 v16, v16, v18
    v_add_f32 v17, v17, v19
    v_add_f32 v20, v20, v22
    v_add_f32 v21, v21, v23
    v_add_f32 v16, v16, v20
    v_add_f32 v17, v17, v21
    v_add_f32 v8, v16, v24
    v_add_f32 v10, v17, v25
    global_store_dwordx4 v5, v[8:11], s[30:31] sc1
LA_uk0:
    s_barrier
    s_branch LA_uk
LA_u80:
    s_sleep 30
LA_uk:
    s_cmp_lt_u32 s3, 6
    s_cbranch_scc0 LA_nouk
    s_mul_i32 s40, s41, 192
    s_lshl_b32 s42, s3, 5
    s_add_u32 s40, s40, s42
    s_add_u32 s40, s40, 0
    v_lshl_add_u32 v4, v3, 3, s40
    v_mul_u32_u24 v4, 12288, v4
    s_mul_i32 s40, s47, 384
    v_add_u32 v4, s40, v4
    v_lshl_add_u32 v5, v2, 3, v4
    v_lshl_add_u32 v4, v2, 4, v4
    global_load_dwordx4 v[128:131], v4, s[10:11] nt
    global_load_dwordx2 v[160:161], v5, s[10:11] offset:256 nt
    v_add_u32 v4, 12288, v4
    v_add_u32 v5, 12288, v5
    global_load_dwordx4 v[132:135], v4, s[10:11] nt
    global_load_dwordx2 v[162:163], v5, s[10:11] offset:256 nt
    v_add_u32 v4, 12288, v4
    v_add_u32 v5, 12288, v5
    global_load_dwordx4 v[136:139], v4, s[10:11] nt
    global_load_dwordx2 v[164:165], v5, s[10:11] offset:256 nt
    v_add_u32 v4, 12288, v4
    v_add_u32 v5, 12288, v5
    global_load_dwordx4 v[140:143], v4, s[10:11] nt
    global_load_dwordx2 v[166:167], v5, s[10:11] offset:256 nt
    v_add_u32 v4, 12288, v4
    v_add_u32 v5, 12288, v5
    global_load_dwordx4 v[144:147], v4, s[10:11] nt
    global_load_dwordx2 v[168:169], v5, s[10:11] offset:256 nt
    v_add_u32 v4, 12288, v4
    v_add_u32 v5, 12288, v5
    global_load_dwordx4 v[148:151], v4, s[10:11] nt
    global_load_dwordx2 v[170:171], v5, s[10:11] offset:256 nt
    v_add_u32 v4, 12288, v4
    v_add_u32 v5, 12288, v5
    global_load_dwordx4 v[152:155], v4, s[10:11] nt
    global_load_dwordx2 v[172:173], v5, s[10:11] offset:256 nt
    v_add_u32 v4, 12288, v4
    v_add_u32 v5, 12288, v5
    global_load_dwordx4 v[156:159], v4, s[10:11] nt
    global_load_dwordx2 v[174:175], v5, s[10:11] offset:256 nt
LA_nouk:
    s_mul_i32 s40, s47, 15360
    s_mul_i32 s42, s3, 192
    s_add_u32 s40, s40, s42
    s_add_u32 s40, s40, 1179648
    v_min_u32 v5, 11, v2
    v_mul_u32_u24 v4, 1536, v3
    v_lshl_add_u32 v4, v5, 4, v4
    v_add_u32 v4, s40, v4
    v_add_u32 v7, 6144, v4
    v_add_u32 v13, 12288, v4
    s_mul_i32 s40, s3, 48
    v_and_b32 v8, 1, v3
    v_lshl_add_u32 v5, v5, 1, v8
    v_lshl_add_u32 v5, v5, 1, s40
    v_lshlrev_b32 v40, 5, v2
    v_lshlrev_b32 v41, 4, v2
    v_lshlrev_b32 v42, 1, v5
    s_mul_i32 s40, s44, 384
    s_lshl_b32 s42, s3, 6
    s_add_u32 s40, s40, s42
    s_add_u32 s40, s40, 360448
    v_lshl_add_u32 v6, v3, 4, s40
    s_waitcnt vmcnt(0)
    v_readfirstlane_b32 s32, v15
    s_mul_i32 s32, s32, 0x9E3779B1
    s_add_u32 s32, s32, 0x7F4A7C15
    v_mov_b32 v24, 0
    v_mov_b32 v25, s32
    v_mov_b32 v26, 0
    v_mov_b32 v27, s32
    global_load_dwordx4 v[16:19], v4, s[30:31] sc1
    global_load_dwordx4 v[20:23], v7, s[30:31] sc1
    s_mov_b32 exec_lo, 0xffffffff
    s_mov_b32 exec_hi, 0x0
    global_load_dwordx4 v[24:27], v13, s[30:31] sc1
    s_mov_b64 exec, -1
    s_cmp_lt_u32 s3, 6
    s_cbranch_scc0 LA_nounp
    v_lshlrev_b32 v64, 16, v128
    v_and_b32 v65, 0xffff0000, v128
    v_lshlrev_b32 v66, 16, v129
    v_and_b32 v67, 0xffff0000, v129
    v_lshlrev_b32 v68, 16, v130
    v_and_b32 v69, 0xffff0000, v130
    v_lshlrev_b32 v70, 16, v131
    v_and_b32 v71, 0xffff0000, v131
    v_lshlrev_b32 v72, 16, v160
    v_and_b32 v73, 0xffff0000, v160
    v_lshlrev_b32 v74, 16, v161
    v_and_b32 v75, 0xffff0000, v161
    v_lshlrev_b32 v76, 16, v132
    v_and_b32 v77, 0xffff0000, v132
    v_lshlrev_b32 v78, 16, v133
    v_and_b32 v79, 0xffff0000, v133
    v_lshlrev_b32 v80, 16, v134
    v_and_b32 v81, 0xffff0000, v134
    v_lshlrev_b32 v82, 16, v135
    v_and_b32 v83, 0xffff0000, v135
    v_lshlrev_b32 v84, 16, v162
    v_and_b32 v85, 0xffff0000, v162
    v_lshlrev_b32 v86, 16, v163
    v_and_b32 v87, 0xffff0000, v163
    v_lshlrev_b32 v88, 16, v136
    v_and_b32 v89, 0xffff0000, v136
    v_lshlrev_b32 v90, 16, v137
    v_and_b32 v91, 0xffff0000, v137
    v_lshlrev_b32 v92, 16, v138
    v_and_b32 v93, 0xffff0000, v138
    v_lshlrev_b32 v94, 16, v139
    v_and_b32 v95, 0xffff0000, v139
    v_lshlrev_b32 v96, 16, v164
    v_and_b32 v97, 0xffff0000, v164
    v_lshlrev_b32 v98, 16, v165
    v_and_b32 v99, 0xffff0000, v165
    v_lshlrev_b32 v100, 16, v140
    v_and_b32 v101, 0xffff0000, v140
    v_lshlrev_b32 v102, 16, v141
    v_and_b32 v103, 0xffff0000, v141
    v_lshlrev_b32 v104, 16, v142
    v_and_b32 v105, 0xffff0000, v142
    v_lshlrev_b32 v106, 16, v143
    v_and_b32 v107, 0xffff0000, v143
    v_lshlrev_b32 v108, 16, v166
    v_and_b32 v109, 0xffff0000, v166
    v_lshlrev_b32 v110, 16, v167
    v_and_b32 v111, 0xffff0000, v167
    v_lshlrev_b32 v112, 16, v144
    v_and_b32 v113, 0xffff0000, v144
    v_lshlrev_b32 v114, 16, v145
    v_and_b32 v115, 0xffff0000, v145
    v_lshlrev_b32 v116, 16, v146
    v_and_b32 v117, 0xffff0000, v146
    v_lshlrev_b32 v118, 16, v147
    v_and_b32 v119, 0xffff0000, v147
    v_lshlrev_b32 v120, 16, v168
    v_and_b32 v121, 0xffff0000, v168
    v_lshlrev_b32 v122, 16, v169
    v_and_b32 v123, 0xffff0000, v169
    v_lshlrev_b32 v124, 16, v148
    v_and_b32 v125, 0xffff0000, v148
    v_lshlrev_b32 v126, 16, v149
    v_and_b32 v127, 0xffff0000, v149
    v_lshlrev_b32 v176, 16, v150
    v_and_b32 v177, 0xffff0000, v150
    v_lshlrev_b32 v178, 16, v151
    v_and_b32 v179, 0xffff0000, v151
    v_lshlrev_b32 v180, 16, v170
    v_and_b32 v181, 0xffff0000, v170
    v_lshlrev_b32 v182, 16, v171
    v_and_b32 v183, 0xffff0000, v171
    v_lshlrev_b32 v184, 16, v152
    v_and_b32 v185, 0xffff0000, v152
    v_lshlrev_b32 v186, 16, v153
    v_and_b32 v187, 0xffff0000, v153
    v_lshlrev_b32 v188, 16, v154
    v_and_b32 v189, 0xffff0000, v154
    v_lshlrev_b32 v190, 16, v155
    v_and_b32 v191, 0xffff0000, v155
    v_lshlrev_b32 v192, 16, v172
    v_and_b32 v193, 0xffff0000, v172
    v_lshlrev_b32 v194, 16, v173
    v_and_b32 v195, 0xffff0000, v173
    v_lshlrev_b32 v196, 16, v156
    v_and_b32 v197, 0xffff0000, v156
    v_lshlrev_b32 v198, 16, v157
    v_and_b32 v199, 0xffff0000, v157
    v_lshlrev_b32 v200, 16, v158
    v_and_b32 v201, 0xffff0000, v158
    v_lshlrev_b32 v202, 16, v159
    v_and_b32 v203, 0xffff0000, v159
    v_lshlrev_b32 v204, 16, v174
    v_and_b32 v205, 0xffff0000, v174
    v_lshlrev_b32 v206, 16, v175
    v_and_b32 v207, 0xffff0000, v175
LA_nounp:
    s_branch Lc_3
Lp_1:
    global_load_dwordx4 v[16:19], v4, s[30:31] sc1
    global_load_dwordx4 v[20:23], v7, s[30:31] sc1
    s_mov_b32 exec_lo, 0xffffffff
    s_mov_b32 exec_hi, 0x0
    global_load_dwordx4 v[24:27], v13, s[30:31] sc1
    s_mov_b64 exec, -1
Lc_3:
    s_waitcnt vmcnt(0)
    v_cmp_ne_u32 vcc, s32, v17
    v_cmp_ne_u32 s[50:51], s32, v19
    s_or_b64 vcc, vcc, s[50:51]
    v_cmp_ne_u32 s[50:51], s32, v21
    s_or_b64 vcc, vcc, s[50:51]
    v_cmp_ne_u32 s[50:51], s32, v23
    s_or_b64 vcc, vcc, s[50:51]
    v_cmp_ne_u32 s[50:51], s32, v25
    s_or_b64 vcc, vcc, s[50:51]
    v_cmp_ne_u32 s[50:51], s32, v27
    s_or_b64 vcc, vcc, s[50:51]
    s_cbranch_vccz Ld_2
    s_add_u32 s33, s33, 1
    s_cmp_gt_u32 s33, 200000
    s_cbranch_scc1 Ld_2
    s_sleep 1
    s_branch Lp_1
Ld_2:
    s_setprio 3
    v_add_f32 v16, v16, v20
    v_add_f32 v18, v18, v22
    v_add_f32 v16, v16, v24
    v_add_f32 v18, v18, v26
    s_nop 1
    v_permlane16_swap_b32 v16, v18
    v_add_f32 v16, v16, v18
    v_mov_b32 v18, v16
    s_nop 1
    v_permlane32_swap_b32 v16, v18
    v_add_f32 v16, v16, v18
    v_cvt_pk_bf16_f32 v16, v16, v16
    v_and_b32 v17, 0xffff0000, v16
    ds_write_b32 v42, v17 offset:36352
    ds_write_b16 v5, v16 offset:2816
    s_waitcnt lgkmcnt(0)
    s_barrier
    s_cmp_lt_u32 s3, 6
    s_cbranch_scc0 LA_nos3
    ds_read_b128 v[44:47], v40 offset:36352
    ds_read_b128 v[48:51], v40 offset:36368
    ds_read_b128 v[52:55], v41 offset:36864
    s_waitcnt lgkmcnt(2)
    v_pk_mul_f32 v[208:209], v[64:65], v[44:45]
    v_pk_mul_f32 v[210:211], v[76:77], v[44:45]
    v_pk_mul_f32 v[212:213], v[88:89], v[44:45]
    v_pk_mul_f32 v[214:215], v[100:101], v[44:45]
    v_pk_mul_f32 v[216:217], v[112:113], v[44:45]
    v_pk_mul_f32 v[218:219], v[124:125], v[44:45]
    v_pk_mul_f32 v[220:221], v[184:185], v[44:45]
    v_pk_mul_f32 v[222:223], v[196:197], v[44:45]
    v_pk_fma_f32 v[208:209], v[66:67], v[46:47], v[208:209]
    v_pk_fma_f32 v[210:211], v[78:79], v[46:47], v[210:211]
    v_pk_fma_f32 v[212:213], v[90:91], v[46:47], v[212:213]
    v_pk_fma_f32 v[214:215], v[102:103], v[46:47], v[214:215]
    v_pk_fma_f32 v[216:217], v[114:115], v[46:47], v[216:217]
    v_pk_fma_f32 v[218:219], v[126:127], v[46:47], v[218:219]
    v_pk_fma_f32 v[220:221], v[186:187], v[46:47], v[220:221]
    v_pk_fma_f32 v[222:223], v[198:199], v[46:47], v[222:223]
    s_waitcnt lgkmcnt(1)
    v_pk_fma_f32 v[208:209], v[68:69], v[48:49], v[208:209]
    v_pk_fma_f32 v[210:211], v[80:81], v[48:49], v[210:211]
    v_pk_fma_f32 v[212:213], v[92:93], v[48:49], v[212:213]
    v_pk_fma_f32 v[214:215], v[104:105], v[48:49], v[214:215]
    v_pk_fma_f32 v[216:217], v[116:117], v[48:49], v[216:217]
    v_pk_fma_f32 v[218:219], v[176:177], v[48:49], v[218:219]
    v_pk_fma_f32 v[220:221], v[188:189], v[48:49], v[220:221]
    v_pk_fma_f32 v[222:223], v[200:201], v[48:49], v[222:223]
    v_pk_fma_f32 v[208:209], v[70:71], v[50:51], v[208:209]
    v_pk_fma_f32 v[210:211], v[82:83], v[50:51], v[210:211]
    v_pk_fma_f32 v[212:213], v[94:95], v[50:51], v[212:213]
    v_pk_fma_f32 v[214:215], v[106:107], v[50:51], v[214:215]
    v_pk_fma_f32 v[216:217], v[118:119], v[50:51], v[216:217]
    v_pk_fma_f32 v[218:219], v[178:179], v[50:51], v[218:219]
    v_pk_fma_f32 v[220:221], v[190:191], v[50:51], v[220:221]
    v_pk_fma_f32 v[222:223], v[202:203], v[50:51], v[222:223]
    s_waitcnt lgkmcnt(0)
    v_pk_fma_f32 v[208:209], v[72:73], v[52:53], v[208:209]
    v_pk_fma_f32 v[210:211], v[84:85], v[52:53], v[210:211]
    v_pk_fma_f32 v[212:213], v[96:97], v[52:53], v[212:213]
    v_pk_fma_f32 v[214:215], v[108:109], v[52:53], v[214:215]
    v_pk_fma_f32 v[216:217], v[120:121], v[52:53], v[216:217]
    v_pk_fma_f32 v[218:219], v[180:181], v[52:53], v[218:219]
    v_pk_fma_f32 v[220:221], v[192:193], v[52:53], v[220:221]
    v_pk_fma_f32 v[222:223], v[204:205], v[52:53], v[222:223]
    v_pk_fma_f32 v[208:209], v[74:75], v[54:55], v[208:209]
    v_pk_fma_f32 v[210:211], v[86:87], v[54:55], v[210:211]
    v_pk_fma_f32 v[212:213], v[98:99], v[54:55], v[212:213]
    v_pk_fma_f32 v[214:215], v[110:111], v[54:55], v[214:215]
    v_pk_fma_f32 v[216:217], v[122:123], v[54:55], v[216:217]
    v_pk_fma_f32 v[218:219], v[182:183], v[54:55], v[218:219]
    v_pk_fma_f32 v[220:221], v[194:195], v[54:55], v[220:221]
    v_pk_fma_f32 v[222:223], v[206:207], v[54:55], v[222:223]
    v_add_f32 v24, v208, v209
    v_add_f32 v25, v210, v211
    v_add_f32 v26, v212, v213
    v_add_f32 v27, v214, v215
    v_add_f32 v28, v216, v217
    v_add_f32 v29, v218, v219
    v_add_f32 v30, v220, v221
    v_add_f32 v31, v222, v223
    v_add_f32_dpp v32, v24, v24 row_ror:8 row_mask:0xf bank_mask:0x3
    v_add_f32_dpp v33, v25, v25 row_ror:8 row_mask:0xf bank_mask:0x3
    v_add_f32_dpp v34, v26, v26 row_ror:8 row_mask:0xf bank_mask:0x3
    v_add_f32_dpp v35, v27, v27 row_ror:8 row_mask:0xf bank_mask:0x3
    v_add_f32_dpp v32, v28, v28 row_ror:8 row_mask:0xf bank_mask:0xc
    v_add_f32_dpp v33, v29, v29 row_ror:8 row_mask:0xf bank_mask:0xc
    v_add_f32_dpp v34, v30, v30 row_ror:8 row_mask:0xf bank_mask:0xc
    v_add_f32_dpp v35, v31, v31 row_ror:8 row_mask:0xf bank_mask:0xc
    v_add_f32_dpp v36, v32, v32 row_shl:4 row_mask:0xf bank_mask:0x5
    v_add_f32_dpp v37, v33, v33 row_shl:4 row_mask:0xf bank_mask:0x5
    s_nop 0
    v_add_f32_dpp v36, v34, v34 row_shr:4 row_mask:0xf bank_mask:0xa
    v_add_f32_dpp v37, v35, v35 row_shr:4 row_mask:0xf bank_mask:0xa
    s_nop 0
    v_add_f32_dpp v36, v36, v36 quad_perm:[2,3,0,1] row_mask:0xf bank_mask:0xf
    v_add_f32_dpp v37, v37, v37 quad_perm:[2,3,0,1] row_mask:0xf bank_mask:0xf
    s_nop 0
    v_add_f32_dpp v36, v36, v36 quad_perm:[1,0,3,2] row_mask:0xf bank_mask:0xf
    v_add_f32_dpp v37, v37, v37 quad_perm:[1,0,3,2] row_mask:0xf bank_mask:0xf
    v_cvt_pk_bf16_f32 v36, v36, v37
    v_min_u32 v36, -2, v36
    s_nop 1
    v_mov_b32_dpp v37, v36 row_shl:4 row_mask:0xf bank_mask:0xf
    v_mov_b32_dpp v38, v36 row_shl:8 row_mask:0xf bank_mask:0xf
    v_mov_b32_dpp v39, v36 row_shl:12 row_mask:0xf bank_mask:0xf
    s_mov_b32 exec_lo, 0x10001
    s_mov_b32 exec_hi, 0x10001
    global_store_dwordx4 v6, v[36:39], s[30:31] sc1
    s_mov_b64 exec, -1
    s_setprio 0
    s_barrier
    v_perm_b32 v64, v132, v128, s34
    v_perm_b32 v65, v140, v136, s34
    v_perm_b32 v66, v148, v144, s34
    v_perm_b32 v67, v156, v152, s34
    v_perm_b32 v68, v132, v128, s35
    v_perm_b32 v69, v140, v136, s35
    v_perm_b32 v70, v148, v144, s35
    v_perm_b32 v71, v156, v152, s35
    v_perm_b32 v72, v133, v129, s34
    v_perm_b32 v73, v141, v137, s34
    v_perm_b32 v74, v149, v145, s34
    v_perm_b32 v75, v157, v153, s34
    v_perm_b32 v76, v133, v129, s35
    v_perm_b32 v77, v141, v137, s35
    v_perm_b32 v78, v149, v145, s35
    v_perm_b32 v79, v157, v153, s35
    v_perm_b32 v80, v134, v130, s34
    v_perm_b32 v81, v142, v138, s34
    v_perm_b32 v82, v150, v146, s34
    v_perm_b32 v83, v158, v154, s34
    v_perm_b32 v84, v134, v130, s35
    v_perm_b32 v85, v142, v138, s35
    v_perm_b32 v86, v150, v146, s35
    v_perm_b32 v87, v158, v154, s35
    v_perm_b32 v88, v135, v131, s34
    v_perm_b32 v89, v143, v139, s34
    v_perm_b32 v90, v151, v147, s34
    v_perm_b32 v91, v159, v155, s34
    v_perm_b32 v92, v135, v131, s35
    v_perm_b32 v93, v143, v139, s35
    v_perm_b32 v94, v151, v147, s35
    v_perm_b32 v95, v159, v155, s35
    v_perm_b32 v96, v162, v160, s34
    v_perm_b32 v97, v166, v164, s34
    v_perm_b32 v98, v170, v168, s34
    v_perm_b32 v99, v174, v172, s34
    v_perm_b32 v100, v162, v160, s35
    v_perm_b32 v101, v166, v164, s35
    v_perm_b32 v102, v170, v168, s35
    v_perm_b32 v103, v174, v172, s35
    v_perm_b32 v104, v163, v161, s34
    v_perm_b32 v105, v167, v165, s34
    v_perm_b32 v106, v171, v169, s34
    v_perm_b32 v107, v175, v173, s34
    v_perm_b32 v108, v163, v161, s35
    v_perm_b32 v109, v167, v165, s35
    v_perm_b32 v110, v171, v169, s35
    v_perm_b32 v111, v175, v173, s35
    s_sleep 20
LA_nsl:
    s_mul_i32 s40, s41, 192
    s_lshl_b32 s42, s3, 5
    s_add_u32 s40, s40, s42
    s_add_u32 s40, s40, 0
    v_lshl_add_u32 v4, v3, 3, s40
    v_mul_u32_u24 v4, 12288, v4
    s_mul_i32 s40, s47, 384
    v_add_u32 v4, s40, v4
    v_lshl_add_u32 v5, v2, 3, v4
    v_lshl_add_u32 v4, v2, 4, v4
    global_load_dwordx4 v[128:131], v4, s[12:13] nt
    global_load_dwordx2 v[160:161], v5, s[12:13] offset:256 nt
    v_add_u32 v4, 12288, v4
    v_add_u32 v5, 12288, v5
    global_load_dwordx4 v[132:135], v4, s[12:13] nt
    global_load_dwordx2 v[162:163], v5, s[12:13] offset:256 nt
    v_add_u32 v4, 12288, v4
    v_add_u32 v5, 12288, v5
    global_load_dwordx4 v[136:139], v4, s[12:13] nt
    global_load_dwordx2 v[164:165], v5, s[12:13] offset:256 nt
    v_add_u32 v4, 12288, v4
    v_add_u32 v5, 12288, v5
    global_load_dwordx4 v[140:143], v4, s[12:13] nt
    global_load_dwordx2 v[166:167], v5, s[12:13] offset:256 nt
    v_add_u32 v4, 12288, v4
    v_add_u32 v5, 12288, v5
    global_load_dwordx4 v[144:147], v4, s[12:13] nt
    global_load_dwordx2 v[168:169], v5, s[12:13] offset:256 nt
    v_add_u32 v4, 12288, v4
    v_add_u32 v5, 12288, v5
    global_load_dwordx4 v[148:151], v4, s[12:13] nt
    global_load_dwordx2 v[170:171], v5, s[12:13] offset:256 nt
    v_add_u32 v4, 12288, v4
    v_add_u32 v5, 12288, v5
    global_load_dwordx4 v[152:155], v4, s[12:13] nt
    global_load_dwordx2 v[172:173], v5, s[12:13] offset:256 nt
    v_add_u32 v4, 12288, v4
    v_add_u32 v5, 12288, v5
    global_load_dwordx4 v[156:159], v4, s[12:13] nt
    global_load_dwordx2 v[174:175], v5, s[12:13] offset:256 nt
    s_waitcnt vmcnt(0)
    v_perm_b32 v176, v132, v128, s34
    v_perm_b32 v177, v140, v136, s34
    v_perm_b32 v178, v148, v144, s34
    v_perm_b32 v179, v156, v152, s34
    v_perm_b32 v180, v132, v128, s35
    v_perm_b32 v181, v140, v136, s35
    v_perm_b32 v182, v148, v144, s35
    v_perm_b32 v183, v156, v152, s35
    v_perm_b32 v184, v133, v129, s34
    v_perm_b32 v185, v141, v137, s34
    v_perm_b32 v186, v149, v145, s34
    v_perm_b32 v187, v157, v153, s34
    v_perm_b32 v188, v133, v129, s35
    v_perm_b32 v189, v141, v137, s35
    v_perm_b32 v190, v149, v145, s35
    v_perm_b32 v191, v157, v153, s35
    v_perm_b32 v192, v134, v130, s34
    v_perm_b32 v193, v142, v138, s34
    v_perm_b32 v194, v150, v146, s34
    v_perm_b32 v195, v158, v154, s34
    v_perm_b32 v196, v134, v130, s35
    v_perm_b32 v197, v142, v138, s35
    v_perm_b32 v198, v150, v146, s35
    v_perm_b32 v199, v158, v154, s35
    v_perm_b32 v200, v135, v131, s34
    v_perm_b32 v201, v143, v139, s34
    v_perm_b32 v202, v151, v147, s34
    v_perm_b32 v203, v159, v155, s34
    v_perm_b32 v204, v135, v131, s35
    v_perm_b32 v205, v143, v139, s35
    v_perm_b32 v206, v151, v147, s35
    v_perm_b32 v207, v159, v155, s35
    v_perm_b32 v208, v162, v160, s34
    v_perm_b32 v209, v166, v164, s34
    v_perm_b32 v210, v170, v168, s34
    v_perm_b32 v211, v174, v172, s34
    v_perm_b32 v212, v162, v160, s35
    v_perm_b32 v213, v166, v164, s35
    v_perm_b32 v214, v170, v168, s35
    v_perm_b32 v215, v174, v172, s35
    v_perm_b32 v216, v163, v161, s34
    v_perm_b32 v217, v167, v165, s34
    v_perm_b32 v218, v171, v169, s34
    v_perm_b32 v219, v175, v173, s34
    v_perm_b32 v220, v163, v161, s35
    v_perm_b32 v221, v167, v165, s35
    v_perm_b32 v222, v171, v169, s35
    v_perm_b32 v223, v175, v173, s35
    s_branch LA_s3d
LA_nos3:
    v_lshlrev_b32 v4, 2, v1
    ds_write_b32 v4, v12 offset:4608
    v_and_b32 v4, 12, v4
    ds_write_b32 v4, v12 offset:38912
    v_mov_b32 v8, 0xff800000
    v_mov_b32 v9, 0
    ds_write_b64 v12, v[8:9] offset:5232
    ds_write_b64 v12, v[8:9] offset:5240
    s_setprio 0
    s_waitcnt lgkmcnt(0)
    s_barrier
LA_s3d:
    s_getreg_b32 s16, hwreg(HW_REG_XCC_ID, 0, 4)
    s_and_b32 s40, s2, 7
    s_lshl_b32 s40, s40, 4
    s_add_u32 s40, s40, 4096
    v_and_b32 v4, 31, v1
    v_lshl_add_u32 v4, v4, 7, s40
Lp_4:
    global_load_dwordx2 v[8:9], v4, s[30:31] sc1
Lc_6:
    s_waitcnt vmcnt(0)
    v_cmp_ne_u32 vcc, s32, v8
    s_cbranch_vccz Ld_5
    s_add_u32 s33, s33, 1
    s_cmp_gt_u32 s33, 200000
    s_cbranch_scc1 Ld_5
    s_sleep 4
    s_branch Lp_4
Ld_5:
    v_cmp_ne_u32 s[38:39], s16, v9
    s_and_b32 s46, s44, 15
    s_lshl_b32 s46, s46, 1
    s_and_b32 s40, s3, 1
    s_add_u32 s46, s46, s40
    s_cmp_ge_u32 s3, 6
    s_cbranch_scc0 LA_n6
    s_lshl_b32 s40, s46, 11
    s_add_u32 s40, s40, 425984
    v_lshl_add_u32 v4, v1, 4, s40
    s_and_b32 s42, s47, 15
    s_lshl_b32 s42, s42, 7
    s_add_u32 s42, s42, 1966080
    v_lshl_add_u32 v5, v1, 11, s42
    s_mov_b32 s48, 0xbcc00000
    s_mov_b32 s42, 0
    s_mov_b32 exec_lo, 0xff
    s_mov_b32 exec_hi, 0x0
Lp_7:
    global_load_dword v8, v5, s[30:31] offset:4 sc1
Lc_9:
    s_waitcnt vmcnt(0)
    v_cmp_ne_u32 vcc, s32, v8
    s_cbranch_vccz Ld_8
    s_add_u32 s33, s33, 1
    s_cmp_gt_u32 s33, 200000
    s_cbranch_scc1 Ld_8
    s_sleep 4
    s_branch Lp_7
Ld_8:
    s_mov_b64 exec, -1
Lp_10:
    global_load_dwordx4 v[28:31], v4, s[30:31] sc1
    global_load_dwordx4 v[32:35], v4, s[30:31] offset:1024 sc1
Lc_12:
    s_waitcnt vmcnt(0)
    v_cmp_ne_u32 vcc, s32, v29
    v_cmp_ne_u32 s[50:51], s32, v31
    s_or_b64 vcc, vcc, s[50:51]
    v_cmp_ne_u32 s[50:51], s32, v33
    s_or_b64 vcc, vcc, s[50:51]
    v_cmp_ne_u32 s[50:51], s32, v35
    s_or_b64 vcc, vcc, s[50:51]
    s_cbranch_vccz Ld_11
    s_add_u32 s33, s33, 1
    s_cmp_gt_u32 s33, 200000
    s_cbranch_scc1 Ld_11
    s_sleep 2
    s_branch Lp_10
Ld_11:
    v_and_b32 v16, 0xffff0000, v28
    v_and_b32 v18, 0xffff0000, v32
    v_max_f32 v20, v16, v18
    v_and_b32 v17, 0xffff0000, v30
    v_and_b32 v19, 0xffff0000, v34
    v_max_f32_dpp v20, v20, v20 row_ror:8 row_mask:0xf bank_mask:0xf
    s_nop 1
    v_max_f32_dpp v20, v20, v20 row_ror:4 row_mask:0xf bank_mask:0xf
    s_nop 1
    v_max_f32_dpp v20, v20, v20 row_ror:2 row_mask:0xf bank_mask:0xf
    s_nop 1
    v_max_f32_dpp v20, v20, v20 row_ror:1 row_mask:0xf bank_mask:0xf
    v_mov_b32 v21, v20
    s_nop 1
    v_permlane16_swap_b32 v20, v21
    v_max_f32 v20, v20, v21
    v_mov_b32 v21, v20
    s_nop 1
    v_permlane32_swap_b32 v20, v21
    v_max_f32 v20, v20, v21
    v_and_b32 v21, 0x7f800000, v20
    v_fma_f32 v27, v21, s48, v20
Le_13:
    v_cmp_ge_f32 s[50:51], v16, v27
    v_cmp_ge_f32 s[52:53], v18, v27
    v_cmp_ge_f32 s[54:55], v17, v27
    v_cmp_ge_f32 s[36:37], v19, v27
    s_bcnt1_i32_b64 s49, s[50:51]
    s_bcnt1_i32_b64 s43, s[52:53]
    s_add_u32 s43, s43, s49
    s_bcnt1_i32_b64 s45, s[54:55]
    s_add_u32 s45, s45, s43
    s_bcnt1_i32_b64 s40, s[36:37]
    s_add_u32 s40, s40, s45
    s_cmp_le_u32 s40, 4
    s_cbranch_scc1 Le_14
    s_add_u32 s42, s42, 1
    s_cmp_gt_u32 s42, 3
    s_cbranch_scc1 Le_14
    v_fmac_f32 v27, 0x3c000000, v21
    s_branch Le_13
Le_14:
    v_mov_b32 v23, s49
    v_mov_b32 v25, s43
    v_mov_b32 v26, s45
    v_mbcnt_lo_u32_b32 v22, s50, 0
    v_mbcnt_lo_u32_b32 v23, s52, v23
    v_mbcnt_lo_u32_b32 v25, s54, v25
    v_mbcnt_lo_u32_b32 v26, s36, v26
    v_mbcnt_hi_u32_b32 v22, s51, v22
    v_mbcnt_hi_u32_b32 v23, s53, v23
    v_mbcnt_hi_u32_b32 v25, s55, v25
    v_mbcnt_hi_u32_b32 v26, s37, v26
    v_cmp_gt_u32 vcc, 4, v22
    s_and_b64 s[50:51], s[50:51], vcc
    v_cmp_gt_u32 vcc, 4, v23
    s_and_b64 s[52:53], s[52:53], vcc
    v_cmp_gt_u32 vcc, 4, v25
    s_and_b64 s[54:55], s[54:55], vcc
    v_cmp_gt_u32 vcc, 4, v26
    s_and_b64 s[36:37], s[36:37], vcc
    s_lshr_b32 s40, s44, 4
    s_lshl_b32 s42, 0x01010101, s40
    s_mov_b32 s43, s42
    v_cndmask_b32 v36, 0, 4, s[54:55]
    v_cndmask_b32 v38, 0, 4, s[36:37]
    v_or_b32 v22, v22, v36
    v_or_b32 v23, v23, v38
    v_cndmask_b32 v36, 15, v22, s[50:51]
    v_cndmask_b32 v38, 15, v23, s[52:53]
    v_mov_b32 v37, s32
    v_mov_b32 v39, s32
    s_lshl_b32 s40, s40, 12
    s_lshl_b32 s49, s46, 3
    s_add_u32 s40, s40, s49
    s_add_u32 s40, s40, 491520
    v_lshrrev_b32 v5, 3, v1
    v_lshl_add_u32 v4, v5, 8, s40
    s_mov_b64 exec, s[42:43]
    s_cmp_eq_u64 s[38:39], 0
    s_cbranch_scc0 Lsf_15
    global_store_dwordx2 v4, v[36:37], s[30:31]
    global_store_dwordx2 v4, v[38:39], s[30:31] offset:2048
    s_branch Lsd_16
Lsf_15:
    global_store_dwordx2 v4, v[36:37], s[30:31] sc1
    global_store_dwordx2 v4, v[38:39], s[30:31] offset:2048 sc1
Lsd_16:
    s_mov_b64 exec, -1
LA_n6:
    s_cmp_eq_u32 s3, 5
    s_cbranch_scc0 LA_noh3
    s_lshl_b32 s40, s47, 11
    s_add_u32 s40, s40, 425984
    v_lshl_add_u32 v4, v1, 4, s40
    s_and_b32 s42, s47, 15
    s_lshl_b32 s42, s42, 7
    s_add_u32 s42, s42, 1966080
    v_lshl_add_u32 v5, v1, 11, s42
    s_mov_b32 s48, 0xbcc00000
    s_mov_b32 s42, 0
    s_mov_b32 exec_lo, 0xff
    s_mov_b32 exec_hi, 0x0
Lp_17:
    global_load_dword v8, v5, s[30:31] offset:4 sc1
Lc_19:
    s_waitcnt vmcnt(0)
    v_cmp_ne_u32 vcc, s32, v8
    s_cbranch_vccz Ld_18
    s_add_u32 s33, s33, 1
    s_cmp_gt_u32 s33, 200000
    s_cbranch_scc1 Ld_18
    s_sleep 4
    s_branch Lp_17
Ld_18:
    s_mov_b64 exec, -1
Lp_20:
    global_load_dwordx4 v[28:31], v4, s[30:31] sc1
    global_load_dwordx4 v[32:35], v4, s[30:31] offset:1024 sc1
Lc_22:
    s_waitcnt vmcnt(0)
    v_cmp_ne_u32 vcc, s32, v29
    v_cmp_ne_u32 s[50:51], s32, v31
    s_or_b64 vcc, vcc, s[50:51]
    v_cmp_ne_u32 s[50:51], s32, v33
    s_or_b64 vcc, vcc, s[50:51]
    v_cmp_ne_u32 s[50:51], s32, v35
    s_or_b64 vcc, vcc, s[50:51]
    s_cbranch_vccz Ld_21
    s_add_u32 s33, s33, 1
    s_cmp_gt_u32 s33, 200000
    s_cbranch_scc1 Ld_21
    s_sleep 2
    s_branch Lp_20
Ld_21:
    v_and_b32 v16, 0xffff0000, v28
    v_and_b32 v18, 0xffff0000, v32
    v_max_f32 v20, v16, v18
    v_and_b32 v17, 0xffff0000, v30
    v_and_b32 v19, 0xffff0000, v34
    v_max_f32_dpp v20, v20, v20 row_ror:8 row_mask:0xf bank_mask:0xf
    s_nop 1
    v_max_f32_dpp v20, v20, v20 row_ror:4 row_mask:0xf bank_mask:0xf
    s_nop 1
    v_max_f32_dpp v20, v20, v20 row_ror:2 row_mask:0xf bank_mask:0xf
    s_nop 1
    v_max_f32_dpp v20, v20, v20 row_ror:1 row_mask:0xf bank_mask:0xf
    v_mov_b32 v21, v20
    s_nop 1
    v_permlane16_swap_b32 v20, v21
    v_max_f32 v20, v20, v21
    v_mov_b32 v21, v20
    s_nop 1
    v_permlane32_swap_b32 v20, v21
    v_max_f32 v20, v20, v21
    v_and_b32 v21, 0x7f800000, v20
    v_fma_f32 v27, v21, s48, v20
Le_23:
    v_cmp_ge_f32 s[50:51], v16, v27
    v_cmp_ge_f32 s[52:53], v18, v27
    v_cmp_ge_f32 s[54:55], v17, v27
    v_cmp_ge_f32 s[36:37], v19, v27
    s_bcnt1_i32_b64 s49, s[50:51]
    s_bcnt1_i32_b64 s43, s[52:53]
    s_add_u32 s43, s43, s49
    s_bcnt1_i32_b64 s45, s[54:55]
    s_add_u32 s45, s45, s43
    s_bcnt1_i32_b64 s40, s[36:37]
    s_add_u32 s40, s40, s45
    s_cmp_le_u32 s40, 4
    s_cbranch_scc1 Le_24
    s_add_u32 s42, s42, 1
    s_cmp_gt_u32 s42, 3
    s_cbranch_scc1 Le_24
    v_fmac_f32 v27, 0x3c000000, v21
    s_branch Le_23
Le_24:
    v_mov_b32 v23, s49
    v_mov_b32 v25, s43
    v_mov_b32 v26, s45
    v_mbcnt_lo_u32_b32 v22, s50, 0
    v_mbcnt_lo_u32_b32 v23, s52, v23
    v_mbcnt_lo_u32_b32 v25, s54, v25
    v_mbcnt_lo_u32_b32 v26, s36, v26
    v_mbcnt_hi_u32_b32 v22, s51, v22
    v_mbcnt_hi_u32_b32 v23, s53, v23
    v_mbcnt_hi_u32_b32 v25, s55, v25
    v_mbcnt_hi_u32_b32 v26, s37, v26
    v_cmp_gt_u32 vcc, 4, v22
    s_and_b64 s[50:51], s[50:51], vcc
    v_cmp_gt_u32 vcc, 4, v23
    s_and_b64 s[52:53], s[52:53], vcc
    v_cmp_gt_u32 vcc, 4, v25
    s_and_b64 s[54:55], s[54:55], vcc
    v_cmp_gt_u32 vcc, 4, v26
    s_and_b64 s[36:37], s[36:37], vcc
    v_lshlrev_b32 v5, 6, v1
    v_add_u32 v6, 4096, v5
    v_and_or_b32 v16, v28, 63, v5
    v_and_or_b32 v18, v32, 63, v6
    v_and_or_b32 v17, v30, 63, v5
    v_and_or_b32 v19, v34, 63, v6
    v_lshlrev_b32 v4, 2, v1
    v_mov_b32 v20, 999
    v_mov_b32 v21, 998
    v_add_u32 v27, 64, v1
    v_lshlrev_b32 v22, 2, v22
    v_lshlrev_b32 v23, 2, v23
    v_lshlrev_b32 v25, 2, v25
    v_lshlrev_b32 v26, 2, v26
    s_mov_b64 exec, 15
    ds_write_b32 v4, v16 offset:3840
    ds_write_b32 v4, v20 offset:3856
    s_mov_b64 exec, s[50:51]
    ds_write_b32 v22, v16 offset:3840
    ds_write_b32 v22, v1 offset:3856
    s_mov_b64 exec, s[52:53]
    ds_write_b32 v23, v18 offset:3840
    ds_write_b32 v23, v27 offset:3856
    s_or_b64 s[42:43], s[54:55], s[36:37]
    s_cbranch_scc0 LA_n2
    s_mov_b64 exec, s[54:55]
    ds_write_b32 v25, v17 offset:3840
    ds_write_b32 v25, v21 offset:3856
    s_mov_b64 exec, s[36:37]
    ds_write_b32 v26, v19 offset:3840
    ds_write_b32 v26, v21 offset:3856
LA_n2:
    s_mov_b64 exec, -1
LA_noh3:
    v_and_b32 v4, 3, v2
    v_lshlrev_b32 v4, 2, v4
    s_mul_i32 s40, s41, 384
    s_lshl_b32 s42, s3, 6
    s_add_u32 s42, s40, s42
    v_lshl_add_u32 v6, v3, 4, s42
    v_and_b32 v7, 31, v1
    v_lshl_add_u32 v7, v7, 1, s42
    s_movk_i32 s55, 1536
    s_waitcnt lgkmcnt(0)
    s_barrier
    s_setprio 3
    s_cmp_lt_u32 s3, 6
    s_cbranch_scc0 LA_noe
    ds_read_b32 v5, v4 offset:3840
    ds_read_b128 v[8:11], v12 offset:3840
    s_waitcnt lgkmcnt(1)
    v_mad_u32_u24 v5, v5, s55, v6
    global_load_dwordx4 v[224:227], v5, s[6:7]
    s_waitcnt lgkmcnt(0)
    v_mad_u32_u24 v8, v8, s55, v7
    global_load_ushort v232, v8, s[6:7]
    v_mad_u32_u24 v9, v9, s55, v7
    global_load_ushort v233, v9, s[6:7]
    v_mad_u32_u24 v10, v10, s55, v7
    global_load_ushort v234, v10, s[6:7]
    v_mad_u32_u24 v11, v11, s55, v7
    global_load_ushort v235, v11, s[6:7]
    s_mul_i32 s40, s3, 3072
    s_add_u32 s40, s40, 6144
    v_lshl_add_u32 v4, v1, 4, s40
    s_waitcnt vmcnt(4)
    v_mfma_f32_16x16x32_bf16 v[16:19], v[224:227], v[64:67], 0
    v_mfma_f32_16x16x32_bf16 v[20:23], v[224:227], v[68:71], 0
    v_mfma_f32_16x16x32_bf16 v[24:27], v[224:227], v[72:75], 0
    v_mfma_f32_16x16x32_bf16 v[28:31], v[224:227], v[76:79], 0
    v_mfma_f32_16x16x32_bf16 v[32:35], v[224:227], v[80:83], 0
    v_mfma_f32_16x16x32_bf16 v[36:39], v[224:227], v[84:87], 0
    v_mfma_f32_16x16x32_bf16 v[40:43], v[224:227], v[88:91], 0
    v_mfma_f32_16x16x32_bf16 v[44:47], v[224:227], v[92:95], 0
    v_mfma_f32_16x16x32_bf16 v[48:51], v[224:227], v[96:99], 0
    v_mfma_f32_16x16x32_bf16 v[52:55], v[224:227], v[100:103], 0
    v_mfma_f32_16x16x32_bf16 v[56:59], v[224:227], v[104:107], 0
    v_mfma_f32_16x16x32_bf16 v[60:63], v[224:227], v[108:111], 0
    v_permlane16_swap_b32 v16, v20
    v_permlane16_swap_b32 v24, v28
    v_permlane16_swap_b32 v17, v21
    v_permlane16_swap_b32 v25, v29
    v_permlane16_swap_b32 v18, v22
    v_permlane16_swap_b32 v26, v30
    v_permlane16_swap_b32 v19, v23
    v_permlane16_swap_b32 v27, v31
    v_permlane32_swap_b32 v16, v24
    v_permlane32_swap_b32 v17, v25
    v_permlane32_swap_b32 v18, v26
    v_permlane32_swap_b32 v19, v27
    ds_write_b128 v4, v[16:19] offset:0
    v_permlane16_swap_b32 v32, v36
    v_permlane16_swap_b32 v40, v44
    v_permlane16_swap_b32 v33, v37
    v_permlane16_swap_b32 v41, v45
    v_permlane16_swap_b32 v34, v38
    v_permlane16_swap_b32 v42, v46
    v_permlane16_swap_b32 v35, v39
    v_permlane16_swap_b32 v43, v47
    v_permlane32_swap_b32 v32, v40
    v_permlane32_swap_b32 v33, v41
    v_permlane32_swap_b32 v34, v42
    v_permlane32_swap_b32 v35, v43
    ds_write_b128 v4, v[32:35] offset:1024
    v_permlane16_swap_b32 v48, v52
    v_permlane16_swap_b32 v56, v60
    v_permlane16_swap_b32 v49, v53
    v_permlane16_swap_b32 v57, v61
    v_permlane16_swap_b32 v50, v54
    v_permlane16_swap_b32 v58, v62
    v_permlane16_swap_b32 v51, v55
    v_permlane16_swap_b32 v59, v63
    v_permlane32_swap_b32 v48, v56
    v_permlane32_swap_b32 v49, v57
    v_permlane32_swap_b32 v50, v58
    v_permlane32_swap_b32 v51, v59
    ds_write_b128 v4, v[48:51] offset:2048
    s_branch LA_b4
LA_noe:
LA_g:
    s_setprio 1
    s_and_b32 s42, s3, 1
    s_mul_i32 s40, s42, 768
    s_add_u32 s40, s40, 24576
    v_lshl_add_u32 v248, v2, 5, s40
    v_lshl_add_u32 v249, v2, 4, s40
    s_lshl_b32 s40, s42, 8
    s_add_u32 s40, s40, 4608
    v_and_b32 v250, 1, v2
    v_lshlrev_b32 v250, 7, v250
    v_lshl_add_u32 v250, v3, 4, v250
    v_add_u32 v250, s40, v250
    v_lshl_add_u32 v251, v1, 1, s40
    s_lshl_b32 s43, s42, 6
    v_add_u32 v7, s43, v1
    s_lshl_b32 s40, s44, 11
    s_add_u32 s40, s40, 1703936
    v_lshl_add_u32 v6, v7, 4, s40
    ds_read_b128 v[24:27], v12 offset:3856
    s_lshl_b32 s40, s44, 7
    s_add_u32 s40, s40, s43
    v_lshl_add_u32 v4, v3, 3, s40
    v_mul_u32_u24 v4, 384, v4
    v_add_u32 v4, 2097152, v4
    v_lshl_add_u32 v5, v2, 3, v4
    v_lshl_add_u32 v4, v2, 4, v4
    v_add_u32 v10, 12288, v4
    v_add_u32 v11, 12288, v5
    s_mov_b64 s[52:53], 0
    s_mov_b32 s48, 0x01010101
    v_mov_b32 v22, 0xff800000
    s_lshl_b32 s40, s42, 3
    v_mov_b32 v23, s40
    s_waitcnt lgkmcnt(0)
    v_cmp_eq_u32 s[54:55], v24, v7
    v_cmp_eq_u32 vcc, v25, v7
    s_or_b64 s[54:55], s[54:55], vcc
    v_cmp_eq_u32 vcc, v26, v7
    s_or_b64 s[54:55], s[54:55], vcc
    v_cmp_eq_u32 vcc, v27, v7
    s_or_b64 s[54:55], s[54:55], vcc
    s_sleep 30
LA_g0:
    global_load_dwordx4 v[28:31], v6, s[30:31] sc1
    s_waitcnt vmcnt(0)
    v_cmp_eq_u32 vcc, s32, v29
    v_cmp_eq_u32 s[50:51], s32, v31
    s_and_b64 s[50:51], s[50:51], vcc
    s_andn2_b64 s[42:43], s[50:51], s[52:53]
    s_mov_b64 s[52:53], s[50:51]
    s_cbranch_scc0 LA_gn
    s_lshr_b32 s40, s42, 0
    s_and_b32 s40, s40, s48
    s_cbranch_scc0 LA_gs0_0
    s_and_b32 s38, s40, 0x101
    s_lshr_b32 s39, s40, 16
    s_mul_i32 s38, s38, 0x101
    s_mul_i32 s39, s39, 0x101
    s_and_b32 s38, s38, 0x10001
    s_and_b32 s39, s39, 0x10001
    s_mul_i32 exec_lo, s38, 0xffff
    s_mul_i32 exec_hi, s39, 0xffff
    global_load_dwordx4 v[64:67], v4, s[30:31] offset:0 sc1
    global_load_dwordx2 v[96:97], v5, s[30:31] offset:256 sc1
LA_gs0_0:
    s_lshr_b32 s40, s42, 1
    s_and_b32 s40, s40, s48
    s_cbranch_scc0 LA_gs0_1
    s_and_b32 s38, s40, 0x101
    s_lshr_b32 s39, s40, 16
    s_mul_i32 s38, s38, 0x101
    s_mul_i32 s39, s39, 0x101
    s_and_b32 s38, s38, 0x10001
    s_and_b32 s39, s39, 0x10001
    s_mul_i32 exec_lo, s38, 0xffff
    s_mul_i32 exec_hi, s39, 0xffff
    global_load_dwordx4 v[68:71], v4, s[30:31] offset:384 sc1
    global_load_dwordx2 v[98:99], v5, s[30:31] offset:640 sc1
LA_gs0_1:
    s_lshr_b32 s40, s42, 2
    s_and_b32 s40, s40, s48
    s_cbranch_scc0 LA_gs0_2
    s_and_b32 s38, s40, 0x101
    s_lshr_b32 s39, s40, 16
    s_mul_i32 s38, s38, 0x101
    s_mul_i32 s39, s39, 0x101
    s_and_b32 s38, s38, 0x10001
    s_and_b32 s39, s39, 0x10001
    s_mul_i32 exec_lo, s38, 0xffff
    s_mul_i32 exec_hi, s39, 0xffff
    global_load_dwordx4 v[72:75], v4, s[30:31] offset:768 sc1
    global_load_dwordx2 v[100:101], v5, s[30:31] offset:1024 sc1
LA_gs0_2:
    s_lshr_b32 s40, s42, 3
    s_and_b32 s40, s40, s48
    s_cbranch_scc0 LA_gs0_3
    s_and_b32 s38, s40, 0x101
    s_lshr_b32 s39, s40, 16
    s_mul_i32 s38, s38, 0x101
    s_mul_i32 s39, s39, 0x101
    s_and_b32 s38, s38, 0x10001
    s_and_b32 s39, s39, 0x10001
    s_mul_i32 exec_lo, s38, 0xffff
    s_mul_i32 exec_hi, s39, 0xffff
    global_load_dwordx4 v[76:79], v4, s[30:31] offset:1152 sc1
    global_load_dwordx2 v[102:103], v5, s[30:31] offset:1408 sc1
LA_gs0_3:
    s_lshr_b32 s40, s42, 4
    s_and_b32 s40, s40, s48
    s_cbranch_scc0 LA_gs0_4
    s_and_b32 s38, s40, 0x101
    s_lshr_b32 s39, s40, 16
    s_mul_i32 s38, s38, 0x101
    s_mul_i32 s39, s39, 0x101
    s_and_b32 s38, s38, 0x10001
    s_and_b32 s39, s39, 0x10001
    s_mul_i32 exec_lo, s38, 0xffff
    s_mul_i32 exec_hi, s39, 0xffff
    global_load_dwordx4 v[80:83], v4, s[30:31] offset:1536 sc1
    global_load_dwordx2 v[104:105], v5, s[30:31] offset:1792 sc1
LA_gs0_4:
    s_lshr_b32 s40, s42, 5
    s_and_b32 s40, s40, s48
    s_cbranch_scc0 LA_gs0_5
    s_and_b32 s38, s40, 0x101
    s_lshr_b32 s39, s40, 16
    s_mul_i32 s38, s38, 0x101
    s_mul_i32 s39, s39, 0x101
    s_and_b32 s38, s38, 0x10001
    s_and_b32 s39, s39, 0x10001
    s_mul_i32 exec_lo, s38, 0xffff
    s_mul_i32 exec_hi, s39, 0xffff
    global_load_dwordx4 v[84:87], v4, s[30:31] offset:1920 sc1
    global_load_dwordx2 v[106:107], v5, s[30:31] offset:2176 sc1
LA_gs0_5:
    s_lshr_b32 s40, s42, 6
    s_and_b32 s40, s40, s48
    s_cbranch_scc0 LA_gs0_6
    s_and_b32 s38, s40, 0x101
    s_lshr_b32 s39, s40, 16
    s_mul_i32 s38, s38, 0x101
    s_mul_i32 s39, s39, 0x101
    s_and_b32 s38, s38, 0x10001
    s_and_b32 s39, s39, 0x10001
    s_mul_i32 exec_lo, s38, 0xffff
    s_mul_i32 exec_hi, s39, 0xffff
    global_load_dwordx4 v[88:91], v4, s[30:31] offset:2304 sc1
    global_load_dwordx2 v[108:109], v5, s[30:31] offset:2560 sc1
LA_gs0_6:
    s_lshr_b32 s40, s42, 7
    s_and_b32 s40, s40, s48
    s_cbranch_scc0 LA_gs0_7
    s_and_b32 s38, s40, 0x101
    s_lshr_b32 s39, s40, 16
    s_mul_i32 s38, s38, 0x101
    s_mul_i32 s39, s39, 0x101
    s_and_b32 s38, s38, 0x10001
    s_and_b32 s39, s39, 0x10001
    s_mul_i32 exec_lo, s38, 0xffff
    s_mul_i32 exec_hi, s39, 0xffff
    global_load_dwordx4 v[92:95], v4, s[30:31] offset:2688 sc1
    global_load_dwordx2 v[110:111], v5, s[30:31] offset:2944 sc1
LA_gs0_7:
    s_lshr_b32 s40, s43, 0
    s_and_b32 s40, s40, s48
    s_cbranch_scc0 LA_gs1_0
    s_and_b32 s38, s40, 0x101
    s_lshr_b32 s39, s40, 16
    s_mul_i32 s38, s38, 0x101
    s_mul_i32 s39, s39, 0x101
    s_and_b32 s38, s38, 0x10001
    s_and_b32 s39, s39, 0x10001
    s_mul_i32 exec_lo, s38, 0xffff
    s_mul_i32 exec_hi, s39, 0xffff
    global_load_dwordx4 v[112:115], v10, s[30:31] offset:0 sc1
    global_load_dwordx2 v[144:145], v11, s[30:31] offset:256 sc1
LA_gs1_0:
    s_lshr_b32 s40, s43, 1
    s_and_b32 s40, s40, s48
    s_cbranch_scc0 LA_gs1_1
    s_and_b32 s38, s40, 0x101
    s_lshr_b32 s39, s40, 16
    s_mul_i32 s38, s38, 0x101
    s_mul_i32 s39, s39, 0x101
    s_and_b32 s38, s38, 0x10001
    s_and_b32 s39, s39, 0x10001
    s_mul_i32 exec_lo, s38, 0xffff
    s_mul_i32 exec_hi, s39, 0xffff
    global_load_dwordx4 v[116:119], v10, s[30:31] offset:384 sc1
    global_load_dwordx2 v[146:147], v11, s[30:31] offset:640 sc1
LA_gs1_1:
    s_lshr_b32 s40, s43, 2
    s_and_b32 s40, s40, s48
    s_cbranch_scc0 LA_gs1_2
    s_and_b32 s38, s40, 0x101
    s_lshr_b32 s39, s40, 16
    s_mul_i32 s38, s38, 0x101
    s_mul_i32 s39, s39, 0x101
    s_and_b32 s38, s38, 0x10001
    s_and_b32 s39, s39, 0x10001
    s_mul_i32 exec_lo, s38, 0xffff
    s_mul_i32 exec_hi, s39, 0xffff
    global_load_dwordx4 v[120:123], v10, s[30:31] offset:768 sc1
    global_load_dwordx2 v[148:149], v11, s[30:31] offset:1024 sc1
LA_gs1_2:
    s_lshr_b32 s40, s43, 3
    s_and_b32 s40, s40, s48
    s_cbranch_scc0 LA_gs1_3
    s_and_b32 s38, s40, 0x101
    s_lshr_b32 s39, s40, 16
    s_mul_i32 s38, s38, 0x101
    s_mul_i32 s39, s39, 0x101
    s_and_b32 s38, s38, 0x10001
    s_and_b32 s39, s39, 0x10001
    s_mul_i32 exec_lo, s38, 0xffff
    s_mul_i32 exec_hi, s39, 0xffff
    global_load_dwordx4 v[124:127], v10, s[30:31] offset:1152 sc1
    global_load_dwordx2 v[150:151], v11, s[30:31] offset:1408 sc1
LA_gs1_3:
    s_lshr_b32 s40, s43, 4
    s_and_b32 s40, s40, s48
    s_cbranch_scc0 LA_gs1_4
    s_and_b32 s38, s40, 0x101
    s_lshr_b32 s39, s40, 16
    s_mul_i32 s38, s38, 0x101
    s_mul_i32 s39, s39, 0x101
    s_and_b32 s38, s38, 0x10001
    s_and_b32 s39, s39, 0x10001
    s_mul_i32 exec_lo, s38, 0xffff
    s_mul_i32 exec_hi, s39, 0xffff
    global_load_dwordx4 v[128:131], v10, s[30:31] offset:1536 sc1
    global_load_dwordx2 v[152:153], v11, s[30:31] offset:1792 sc1
LA_gs1_4:
    s_lshr_b32 s40, s43, 5
    s_and_b32 s40, s40, s48
    s_cbranch_scc0 LA_gs1_5
    s_and_b32 s38, s40, 0x101
    s_lshr_b32 s39, s40, 16
    s_mul_i32 s38, s38, 0x101
    s_mul_i32 s39, s39, 0x101
    s_and_b32 s38, s38, 0x10001
    s_and_b32 s39, s39, 0x10001
    s_mul_i32 exec_lo, s38, 0xffff
    s_mul_i32 exec_hi, s39, 0xffff
    global_load_dwordx4 v[132:135], v10, s[30:31] offset:1920 sc1
    global_load_dwordx2 v[154:155], v11, s[30:31] offset:2176 sc1
LA_gs1_5:
    s_lshr_b32 s40, s43, 6
    s_and_b32 s40, s40, s48
    s_cbranch_scc0 LA_gs1_6
    s_and_b32 s38, s40, 0x101
    s_lshr_b32 s39, s40, 16
    s_mul_i32 s38, s38, 0x101
    s_mul_i32 s39, s39, 0x101
    s_and_b32 s38, s38, 0x10001
    s_and_b32 s39, s39, 0x10001
    s_mul_i32 exec_lo, s38, 0xffff
    s_mul_i32 exec_hi, s39, 0xffff
    global_load_dwordx4 v[136:139], v10, s[30:31] offset:2304 sc1
    global_load_dwordx2 v[156:157], v11, s[30:31] offset:2560 sc1
LA_gs1_6:
    s_lshr_b32 s40, s43, 7
    s_and_b32 s40, s40, s48
    s_cbranch_scc0 LA_gs1_7
    s_and_b32 s38, s40, 0x101
    s_lshr_b32 s39, s40, 16
    s_mul_i32 s38, s38, 0x101
    s_mul_i32 s39, s39, 0x101
    s_and_b32 s38, s38, 0x10001
    s_and_b32 s39, s39, 0x10001
    s_mul_i32 exec_lo, s38, 0xffff
    s_mul_i32 exec_hi, s39, 0xffff
    global_load_dwordx4 v[140:143], v10, s[30:31] offset:2688 sc1
    global_load_dwordx2 v[158:159], v11, s[30:31] offset:2944 sc1
LA_gs1_7:
    s_mov_b64 exec, -1
    s_cmp_eq_u64 s[52:53], -1
    s_cbranch_scc1 LA_g1
LA_gn:
    s_add_u32 s33, s33, 1
    s_cmp_gt_u32 s33, 200000
    s_cbranch_scc1 LA_g1
    s_sleep 2
    s_branch LA_g0
LA_g1:
    s_setprio 3
    v_cndmask_b32 v16, v28, v22, s[54:55]
    v_mov_b32 v20, v16
    s_nop 1
    v_max_f32_dpp v20, v20, v20 row_ror:8 row_mask:0xf bank_mask:0xf
    s_nop 1
    v_max_f32_dpp v20, v20, v20 row_ror:4 row_mask:0xf bank_mask:0xf
    s_nop 1
    v_max_f32_dpp v20, v20, v20 row_ror:2 row_mask:0xf bank_mask:0xf
    s_nop 1
    v_max_f32_dpp v20, v20, v20 row_ror:1 row_mask:0xf bank_mask:0xf
    v_mov_b32 v21, v20
    s_nop 1
    v_permlane16_swap_b32 v20, v21
    v_max_f32 v20, v20, v21
    v_mov_b32 v21, v20
    s_nop 1
    v_permlane32_swap_b32 v20, v21
    v_max_f32 v20, v20, v21
    v_sub_f32 v16, v16, v20
    v_mul_f32 v16, s56, v16
    v_exp_f32 v16, v16
    s_nop 0
    v_cvt_pk_bf16_f32 v8, v16, v16
    v_mul_f32 v21, v16, v30
    ds_write_b16 v251, v8
    v_and_b32 v9, 0xffff0000, v8
    v_sub_f32 v9, v16, v9
    v_cvt_pk_bf16_f32 v9, v9, v9
    ds_write_b16 v251, v9 offset:128
    s_waitcnt lgkmcnt(0)
    ds_read_b128 v[224:227], v250
    ds_read_b128 v[228:231], v250 offset:64
    v_add_f32_dpp v21, v21, v21 row_ror:8 row_mask:0xf bank_mask:0xf
    s_nop 1
    v_add_f32_dpp v21, v21, v21 row_ror:4 row_mask:0xf bank_mask:0xf
    s_nop 1
    v_add_f32_dpp v21, v21, v21 row_ror:2 row_mask:0xf bank_mask:0xf
    s_nop 1
    v_add_f32_dpp v21, v21, v21 row_ror:1 row_mask:0xf bank_mask:0xf
    v_mov_b32 v22, v21
    s_nop 1
    v_permlane16_swap_b32 v21, v22
    v_add_f32 v21, v21, v22
    v_mov_b32 v22, v21
    s_nop 1
    v_permlane32_swap_b32 v21, v22
    v_add_f32 v21, v21, v22
    v_mov_b32 v8, 1
    ds_write_b64 v23, v[20:21] offset:5216
    s_mov_b64 exec, 1
    ds_add_u32 v12, v8 offset:38920
    s_mov_b64 exec, -1
    s_waitcnt vmcnt(0) lgkmcnt(0)
    v_perm_b32 v16, v68, v64, s34
    v_perm_b32 v17, v76, v72, s34
    v_perm_b32 v18, v84, v80, s34
    v_perm_b32 v19, v92, v88, s34
    s_nop 1
    v_mfma_f32_16x16x32_bf16 v[160:163], v[224:227], v[16:19], 0
    v_perm_b32 v20, v68, v64, s35
    v_perm_b32 v21, v76, v72, s35
    v_perm_b32 v22, v84, v80, s35
    v_perm_b32 v23, v92, v88, s35
    s_nop 1
    v_mfma_f32_16x16x32_bf16 v[164:167], v[224:227], v[20:23], 0
    v_perm_b32 v24, v69, v65, s34
    v_perm_b32 v25, v77, v73, s34
    v_perm_b32 v26, v85, v81, s34
    v_perm_b32 v27, v93, v89, s34
    s_nop 1
    v_mfma_f32_16x16x32_bf16 v[168:171], v[224:227], v[24:27], 0
    v_perm_b32 v28, v69, v65, s35
    v_perm_b32 v29, v77, v73, s35
    v_perm_b32 v30, v85, v81, s35
    v_perm_b32 v31, v93, v89, s35
    s_nop 1
    v_mfma_f32_16x16x32_bf16 v[172:175], v[224:227], v[28:31], 0
    v_perm_b32 v32, v70, v66, s34
    v_perm_b32 v33, v78, v74, s34
    v_perm_b32 v34, v86, v82, s34
    v_perm_b32 v35, v94, v90, s34
    s_nop 1
    v_mfma_f32_16x16x32_bf16 v[176:179], v[224:227], v[32:35], 0
    v_perm_b32 v36, v70, v66, s35
    v_perm_b32 v37, v78, v74, s35
    v_perm_b32 v38, v86, v82, s35
    v_perm_b32 v39, v94, v90, s35
    s_nop 1
    v_mfma_f32_16x16x32_bf16 v[180:183], v[224:227], v[36:39], 0
    v_perm_b32 v16, v71, v67, s34
    v_perm_b32 v17, v79, v75, s34
    v_perm_b32 v18, v87, v83, s34
    v_perm_b32 v19, v95, v91, s34
    s_nop 1
    v_mfma_f32_16x16x32_bf16 v[184:187], v[224:227], v[16:19], 0
    v_perm_b32 v20, v71, v67, s35
    v_perm_b32 v21, v79, v75, s35
    v_perm_b32 v22, v87, v83, s35
    v_perm_b32 v23, v95, v91, s35
    s_nop 1
    v_mfma_f32_16x16x32_bf16 v[188:191], v[224:227], v[20:23], 0
    v_perm_b32 v24, v98, v96, s34
    v_perm_b32 v25, v102, v100, s34
    v_perm_b32 v26, v106, v104, s34
    v_perm_b32 v27, v110, v108, s34
    s_nop 1
    v_mfma_f32_16x16x32_bf16 v[192:195], v[224:227], v[24:27], 0
    v_perm_b32 v28, v98, v96, s35
    v_perm_b32 v29, v102, v100, s35
    v_perm_b32 v30, v106, v104, s35
    v_perm_b32 v31, v110, v108, s35
    s_nop 1
    v_mfma_f32_16x16x32_bf16 v[196:199], v[224:227], v[28:31], 0
    v_perm_b32 v32, v99, v97, s34
    v_perm_b32 v33, v103, v101, s34
    v_perm_b32 v34, v107, v105, s34
    v_perm_b32 v35, v111, v109, s34
    s_nop 1
    v_mfma_f32_16x16x32_bf16 v[200:203], v[224:227], v[32:35], 0
    v_perm_b32 v36, v99, v97, s35
    v_perm_b32 v37, v103, v101, s35
    v_perm_b32 v38, v107, v105, s35
    v_perm_b32 v39, v111, v109, s35
    s_nop 1
    v_mfma_f32_16x16x32_bf16 v[204:207], v[224:227], v[36:39], 0
    v_perm_b32 v40, v116, v112, s34
    v_perm_b32 v41, v124, v120, s34
    v_perm_b32 v42, v132, v128, s34
    v_perm_b32 v43, v140, v136, s34
    s_nop 1
    v_mfma_f32_16x16x32_bf16 v[160:163], v[228:231], v[40:43], v[160:163]
    v_perm_b32 v44, v116, v112, s35
    v_perm_b32 v45, v124, v120, s35
    v_perm_b32 v46, v132, v128, s35
    v_perm_b32 v47, v140, v136, s35
    s_nop 1
    v_mfma_f32_16x16x32_bf16 v[164:167], v[228:231], v[44:47], v[164:167]
    v_perm_b32 v48, v117, v113, s34
    v_perm_b32 v49, v125, v121, s34
    v_perm_b32 v50, v133, v129, s34
    v_perm_b32 v51, v141, v137, s34
    s_nop 1
    v_mfma_f32_16x16x32_bf16 v[168:171], v[228:231], v[48:51], v[168:171]
    v_perm_b32 v52, v117, v113, s35
    v_perm_b32 v53, v125, v121, s35
    v_perm_b32 v54, v133, v129, s35
    v_perm_b32 v55, v141, v137, s35
    s_nop 1
    v_mfma_f32_16x16x32_bf16 v[172:175], v[228:231], v[52:55], v[172:175]
    v_perm_b32 v56, v118, v114, s34
    v_perm_b32 v57, v126, v122, s34
    v_perm_b32 v58, v134, v130, s34
    v_perm_b32 v59, v142, v138, s34
    s_nop 1
    v_mfma_f32_16x16x32_bf16 v[176:179], v[228:231], v[56:59], v[176:179]
    v_perm_b32 v60, v118, v114, s35
    v_perm_b32 v61, v126, v122, s35
    v_perm_b32 v62, v134, v130, s35
    v_perm_b32 v63, v142, v138, s35
    s_nop 1
    v_mfma_f32_16x16x32_bf16 v[180:183], v[228:231], v[60:63], v[180:183]
    v_perm_b32 v40, v119, v115, s34
    v_perm_b32 v41, v127, v123, s34
    v_perm_b32 v42, v135, v131, s34
    v_perm_b32 v43, v143, v139, s34
    s_nop 1
    v_mfma_f32_16x16x32_bf16 v[184:187], v[228:231], v[40:43], v[184:187]
    v_perm_b32 v44, v119, v115, s35
    v_perm_b32 v45, v127, v123, s35
    v_perm_b32 v46, v135, v131, s35
    v_perm_b32 v47, v143, v139, s35
    s_nop 1
    v_mfma_f32_16x16x32_bf16 v[188:191], v[228:231], v[44:47], v[188:191]
    v_perm_b32 v48, v146, v144, s34
    v_perm_b32 v49, v150, v148, s34
    v_perm_b32 v50, v154, v152, s34
    v_perm_b32 v51, v158, v156, s34
    s_nop 1
    v_mfma_f32_16x16x32_bf16 v[192:195], v[228:231], v[48:51], v[192:195]
    v_perm_b32 v52, v146, v144, s35
    v_perm_b32 v53, v150, v148, s35
    v_perm_b32 v54, v154, v152, s35
    v_perm_b32 v55, v158, v156, s35
    s_nop 1
    v_mfma_f32_16x16x32_bf16 v[196:199], v[228:231], v[52:55], v[196:199]
    v_perm_b32 v56, v147, v145, s34
    v_perm_b32 v57, v151, v149, s34
    v_perm_b32 v58, v155, v153, s34
    v_perm_b32 v59, v159, v157, s34
    s_nop 1
    v_mfma_f32_16x16x32_bf16 v[200:203], v[228:231], v[56:59], v[200:203]
    v_perm_b32 v60, v147, v145, s35
    v_perm_b32 v61, v151, v149, s35
    v_perm_b32 v62, v155, v153, s35
    v_perm_b32 v63, v159, v157, s35
    s_nop 1
    v_mfma_f32_16x16x32_bf16 v[204:207], v[228:231], v[60:63], v[204:207]
    v_add_f32 v16, v160, v161
    v_add_f32 v17, v164, v165
    v_add_f32 v18, v168, v169
    v_add_f32 v19, v172, v173
    v_add_f32 v20, v176, v177
    v_add_f32 v21, v180, v181
    v_add_f32 v22, v184, v185
    v_add_f32 v23, v188, v189
    v_add_f32 v24, v192, v193
    v_add_f32 v25, v196, v197
    v_add_f32 v26, v200, v201
    v_add_f32 v27, v204, v205
    s_mov_b32 exec_lo, 0xffff
    s_mov_b32 exec_hi, 0x0
    ds_write_b128 v248, v[16:19]
    ds_write_b128 v248, v[20:23] offset:16
    ds_write_b128 v249, v[24:27] offset:512
    s_mov_b64 exec, -1
    v_mov_b32 v8, 1
    s_mov_b64 exec, 1
    ds_add_u32 v12, v8 offset:38924
    s_mov_b64 exec, -1
    s_branch LA_nov
LA_b4:
    v_mov_b32 v8, 1
    s_mov_b64 exec, 1
    ds_add_u32 v12, v8 offset:38912
    s_mov_b64 exec, -1
    s_cmp_lt_u32 s3, 3
    s_cbranch_scc0 LA_nopub
    v_lshlrev_b32 v6, 4, v0
    v_add_u32 v7, 6144, v6
    s_mul_i32 s40, s44, 3072
    s_add_u32 s40, s40, 557056
    v_add_u32 v6, s40, v6
Lw_25:
    ds_read_b32 v8, v12 offset:38912
    s_waitcnt lgkmcnt(0)
    v_cmp_gt_u32 vcc, 6, v8
    s_cbranch_vccz Lwd_26
    s_add_u32 s33, s33, 1
    s_cmp_gt_u32 s33, 200000
    s_cbranch_scc1 Lwd_26
    s_sleep 1
    s_branch Lw_25
Lwd_26:
    ds_read_b128 v[16:19], v7 offset:0
    ds_read_b128 v[20:23], v7 offset:3072
    ds_read_b128 v[24:27], v7 offset:6144
    ds_read_b128 v[28:31], v7 offset:9216
    ds_read_b128 v[32:35], v7 offset:12288
    ds_read_b128 v[36:39], v7 offset:15360
    s_waitcnt lgkmcnt(0)
    v_add_f32 v16, v16, v20
    v_add_f32 v17, v17, v21
    v_add_f32 v18, v18, v22
    v_add_f32 v19, v19, v23
    v_add_f32 v24, v24, v28
    v_add_f32 v25, v25, v29
    v_add_f32 v26, v26, v30
    v_add_f32 v27, v27, v31
    v_add_f32 v32, v32, v36
    v_add_f32 v33, v33, v37
    v_add_f32 v34, v34, v38
    v_add_f32 v35, v35, v39
    v_add_f32 v16, v16, v24
    v_add_f32 v17, v17, v25
    v_add_f32 v18, v18, v26
    v_add_f32 v19, v19, v27
    v_add_f32 v16, v16, v32
    v_add_f32 v17, v17, v33
    v_add_f32 v18, v18, v34
    v_add_f32 v19, v19, v35
    s_cmp_eq_u64 s[38:39], 0
    s_cbranch_scc0 Lsf_27
    global_store_dwordx4 v6, v[16:19], s[30:31]
    s_branch Lsd_28
Lsf_27:
    global_store_dwordx4 v6, v[16:19], s[30:31] sc1
Lsd_28:
    s_branch LA_l2
LA_nopub:
    s_cmp_eq_u32 s3, 5
    s_cbranch_scc0 LA_w6
    s_mul_i32 s40, s47, 12288
    s_add_u32 s40, s40, 557056
    v_lshl_add_u32 v4, v1, 4, s40
    v_add_u32 v5, 3072, v4
    v_add_u32 v6, 6144, v4
    v_add_u32 v7, 9216, v4
    v_lshl_add_u32 v8, v2, 3, v3
    v_lshlrev_b32 v8, 1, v8
    v_lshl_add_u32 v9, v2, 2, v3
    v_lshlrev_b32 v9, 1, v9
    v_lshlrev_b32 v10, 2, v3
    ds_read_u16 v64, v8 offset:2816
    ds_read_u16 v65, v8 offset:2824
    ds_read_u16 v66, v9 offset:3072
    ds_read_b32 v67, v10 offset:3856
    v_lshl_add_u32 v11, v1, 10, s40
    s_sleep 4
    s_mov_b32 exec_lo, 0xfff
    s_mov_b32 exec_hi, 0x0
Lp_29:
    global_load_dword v16, v11, s[30:31] offset:0 sc1
Lc_31:
    s_waitcnt vmcnt(0)
    v_cmp_eq_u32 vcc, -1, v16
    s_cbranch_vccz Ld_30
    s_add_u32 s33, s33, 1
    s_cmp_gt_u32 s33, 200000
    s_cbranch_scc1 Ld_30
    s_sleep 2
    s_branch Lp_29
Ld_30:
    s_mov_b64 exec, -1
Lp_32:
    global_load_dwordx4 v[16:19], v4, s[30:31] offset:0 sc1
    global_load_dwordx4 v[20:23], v4, s[30:31] offset:1024 sc1
    global_load_dwordx4 v[24:27], v4, s[30:31] offset:2048 sc1
    global_load_dwordx4 v[28:31], v5, s[30:31] offset:0 sc1
    global_load_dwordx4 v[32:35], v5, s[30:31] offset:1024 sc1
    global_load_dwordx4 v[36:39], v5, s[30:31] offset:2048 sc1
    global_load_dwordx4 v[40:43], v6, s[30:31] offset:0 sc1
    global_load_dwordx4 v[44:47], v6, s[30:31] offset:1024 sc1
    global_load_dwordx4 v[48:51], v6, s[30:31] offset:2048 sc1
    global_load_dwordx4 v[52:55], v7, s[30:31] offset:0 sc1
    global_load_dwordx4 v[56:59], v7, s[30:31] offset:1024 sc1
    global_load_dwordx4 v[60:63], v7, s[30:31] offset:2048 sc1
Lc_34:
    s_waitcnt vmcnt(0)
    v_max3_u32 v9, v16, v17, v18
    v_max3_u32 v9, v9, v19, v20
    v_max3_u32 v9, v9, v21, v22
    v_max3_u32 v9, v9, v23, v24
    v_max3_u32 v9, v9, v25, v26
    v_max3_u32 v9, v9, v27, v28
    v_max3_u32 v9, v9, v29, v30
    v_max3_u32 v9, v9, v31, v32
    v_max3_u32 v9, v9, v33, v34
    v_max3_u32 v9, v9, v35, v36
    v_max3_u32 v9, v9, v37, v38
    v_max3_u32 v9, v9, v39, v40
    v_max3_u32 v9, v9, v41, v42
    v_max3_u32 v9, v9, v43, v44
    v_max3_u32 v9, v9, v45, v46
    v_max3_u32 v9, v9, v47, v48
    v_max3_u32 v9, v9, v49, v50
    v_max3_u32 v9, v9, v51, v52
    v_max3_u32 v9, v9, v53, v54
    v_max3_u32 v9, v9, v55, v56
    v_max3_u32 v9, v9, v57, v58
    v_max3_u32 v9, v9, v59, v60
    v_max3_u32 v9, v9, v61, v62
    v_max_u32 v9, v9, v63
    v_cmp_eq_u32 vcc, -1, v9
    s_cbranch_vccz Ld_33
    s_add_u32 s33, s33, 1
    s_cmp_gt_u32 s33, 200000
    s_cbranch_scc1 Ld_33
    s_sleep 1
    s_branch Lp_32
Ld_33:
    s_waitcnt lgkmcnt(0)
    s_movk_i32 s40, 999
    v_cmp_gt_u32 s[52:53], s40, v67
    v_lshlrev_b32 v64, 16, v64
    v_lshlrev_b32 v65, 16, v65
    v_lshlrev_b32 v66, 16, v66
    v_pk_add_f32 v[16:17], v[16:17], v[28:29]
    v_pk_add_f32 v[40:41], v[40:41], v[52:53]
    v_pk_add_f32 v[18:19], v[18:19], v[30:31]
    v_pk_add_f32 v[42:43], v[42:43], v[54:55]
    v_pk_add_f32 v[20:21], v[20:21], v[32:33]
    v_pk_add_f32 v[44:45], v[44:45], v[56:57]
    v_pk_add_f32 v[22:23], v[22:23], v[34:35]
    v_pk_add_f32 v[46:47], v[46:47], v[58:59]
    v_pk_add_f32 v[24:25], v[24:25], v[36:37]
    v_pk_add_f32 v[48:49], v[48:49], v[60:61]
    v_pk_add_f32 v[26:27], v[26:27], v[38:39]
    v_pk_add_f32 v[50:51], v[50:51], v[62:63]
    v_pk_add_f32 v[16:17], v[16:17], v[40:41]
    v_pk_add_f32 v[18:19], v[18:19], v[42:43]
    v_pk_add_f32 v[20:21], v[20:21], v[44:45]
    v_pk_add_f32 v[22:23], v[22:23], v[46:47]
    v_pk_add_f32 v[24:25], v[24:25], v[48:49]
    v_pk_add_f32 v[26:27], v[26:27], v[50:51]
    v_cvt_pk_bf16_f32 v17, v16, v17
    v_cvt_pk_bf16_f32 v19, v18, v19
    v_cvt_pk_bf16_f32 v21, v20, v21
    v_cvt_pk_bf16_f32 v23, v22, v23
    v_cvt_pk_bf16_f32 v25, v24, v25
    v_cvt_pk_bf16_f32 v27, v26, v27
    v_lshlrev_b32 v16, 16, v17
    v_and_b32 v17, 0xffff0000, v17
    v_lshlrev_b32 v18, 16, v19
    v_and_b32 v19, 0xffff0000, v19
    v_lshlrev_b32 v20, 16, v21
    v_and_b32 v21, 0xffff0000, v21
    v_lshlrev_b32 v22, 16, v23
    v_and_b32 v23, 0xffff0000, v23
    v_lshlrev_b32 v24, 16, v25
    v_and_b32 v25, 0xffff0000, v25
    v_lshlrev_b32 v26, 16, v27
    v_and_b32 v27, 0xffff0000, v27
    v_mul_f32 v68, v16, v64
    v_fmac_f32 v68, v20, v65
    v_fmac_f32 v68, v24, v66
    v_mul_f32 v69, v17, v64
    v_fmac_f32 v69, v21, v65
    v_fmac_f32 v69, v25, v66
    v_mul_f32 v70, v18, v64
    v_fmac_f32 v70, v22, v65
    v_fmac_f32 v70, v26, v66
    v_mul_f32 v71, v19, v64
    v_fmac_f32 v71, v23, v65
    v_fmac_f32 v71, v27, v66
    v_add_f32_dpp v68, v68, v68 row_ror:8 row_mask:0xf bank_mask:0xf
    v_add_f32_dpp v69, v69, v69 row_ror:8 row_mask:0xf bank_mask:0xf
    v_add_f32_dpp v70, v70, v70 row_ror:8 row_mask:0xf bank_mask:0xf
    v_add_f32_dpp v71, v71, v71 row_ror:8 row_mask:0xf bank_mask:0xf
    v_add_f32_dpp v68, v68, v68 row_ror:4 row_mask:0xf bank_mask:0xf
    v_add_f32_dpp v69, v69, v69 row_ror:4 row_mask:0xf bank_mask:0xf
    v_add_f32_dpp v70, v70, v70 row_ror:4 row_mask:0xf bank_mask:0xf
    v_add_f32_dpp v71, v71, v71 row_ror:4 row_mask:0xf bank_mask:0xf
    v_add_f32_dpp v68, v68, v68 row_ror:2 row_mask:0xf bank_mask:0xf
    v_add_f32_dpp v69, v69, v69 row_ror:2 row_mask:0xf bank_mask:0xf
    v_add_f32_dpp v70, v70, v70 row_ror:2 row_mask:0xf bank_mask:0xf
    v_add_f32_dpp v71, v71, v71 row_ror:2 row_mask:0xf bank_mask:0xf
    v_add_f32_dpp v68, v68, v68 row_ror:1 row_mask:0xf bank_mask:0xf
    v_add_f32_dpp v69, v69, v69 row_ror:1 row_mask:0xf bank_mask:0xf
    v_add_f32_dpp v70, v70, v70 row_ror:1 row_mask:0xf bank_mask:0xf
    v_add_f32_dpp v71, v71, v71 row_ror:1 row_mask:0xf bank_mask:0xf
    v_permlane16_swap_b32 v68, v69
    s_nop 0
    v_permlane16_swap_b32 v70, v71
    v_add_f32 v68, v68, v69
    v_add_f32 v70, v70, v71
    s_nop 1
    v_permlane32_swap_b32 v68, v70
    v_add_f32 v68, v68, v70
    v_cvt_pk_bf16_f32 v68, v68, v68
    v_and_b32 v68, 0xffff0000, v68
    v_mul_f32 v68, s59, v68
    v_cvt_pk_bf16_f32 v68, v68, v68
    v_and_b32 v68, 0xffff0000, v68
    v_mov_b32 v21, 0xff800000
    v_cndmask_b32 v68, v21, v68, s[52:53]
    v_lshlrev_b32 v11, 3, v3
Lw_35:
    ds_read_b32 v8, v12 offset:38920
    s_waitcnt lgkmcnt(0)
    v_cmp_gt_u32 vcc, 3, v8
    s_cbranch_vccz Lwd_36
    s_add_u32 s33, s33, 1
    s_cmp_gt_u32 s33, 200000
    s_cbranch_scc1 Lwd_36
    s_sleep 1
    s_branch Lw_35
Lwd_36:
    ds_read_b64 v[228:229], v11 offset:5184
    ds_read_b64 v[230:231], v11 offset:5216
    s_waitcnt lgkmcnt(0)
    v_max3_f32 v69, v68, v228, v230
    v_mov_b32 v70, v69
    s_nop 1
    v_permlane16_swap_b32 v69, v70
    v_max_f32 v69, v69, v70
    v_mov_b32 v70, v69
    s_nop 1
    v_permlane32_swap_b32 v69, v70
    v_max_f32 v69, v69, v70
    v_sub_f32 v68, v68, v69
    v_sub_f32 v228, v228, v69
    v_sub_f32 v230, v230, v69
    v_mul_f32 v68, s56, v68
    v_mul_f32 v228, s56, v228
    v_mul_f32 v230, s56, v230
    v_exp_f32 v68, v68
    v_exp_f32 v228, v228
    v_exp_f32 v230, v230
    v_fma_f32 v70, v228, v229, v68
    v_fmac_f32 v70, v230, v231
    v_mov_b32 v71, v70
    s_nop 1
    v_permlane16_swap_b32 v70, v71
    v_add_f32 v70, v70, v71
    v_mov_b32 v71, v70
    s_nop 1
    v_permlane32_swap_b32 v70, v71
    v_add_f32 v70, v70, v71
    v_rcp_f32 v71, v70
    s_nop 0
    v_fma_f32 v72, -v70, v71, 1.0
    v_fma_f32 v71, v72, v71, v71
    v_mul_f32 v73, v68, v71
    v_fma_f32 v72, -v70, v73, v68
    v_fma_f32 v73, v72, v71, v73
    v_cvt_pk_bf16_f32 v73, v73, v73
    v_and_b32 v73, 0xffff0000, v73
    v_mul_f32 v74, v230, v71
    v_mul_f32 v75, v228, v71
    ds_write_b32 v10, v73 offset:5120
    ds_write_b32 v10, v75 offset:5136
    ds_write_b32 v10, v74 offset:5152
    v_mov_b32 v8, 1
    s_mov_b64 exec, 1
    ds_add_u32 v12, v8 offset:38924
    s_mov_b64 exec, -1
    s_branch LA_l2
LA_w6:
    s_cmp_eq_u32 s3, 4
    s_cbranch_scc0 LA_l2
    v_lshlrev_b32 v10, 2, v3
    ds_read_b32 v11, v10 offset:3856
    s_lshl_b32 s40, s47, 13
    s_lshl_b32 s42, s41, 9
    s_add_u32 s40, s40, s42
    s_add_u32 s40, s40, 98304
    v_lshl_add_u32 v6, v3, 11, s40
    v_lshl_add_u32 v4, v2, 4, v6
    v_lshl_add_u32 v5, v2, 3, v6
    v_mul_u32_u24 v9, 384, v3
    v_lshl_add_u32 v7, v2, 4, v9
    v_lshl_add_u32 v9, v2, 3, v9
    v_lshlrev_b32 v10, 3, v3
    v_mov_b32 v24, 0xff800000
    v_mov_b32 v26, 0
    s_movk_i32 s40, 128
    s_waitcnt lgkmcnt(0)
    v_cmp_gt_u32 s[52:53], s40, v11
    v_mov_b32 v16, 0
    v_mov_b32 v17, 0
    v_mov_b32 v18, 0
    v_mov_b32 v19, 0
    v_mov_b32 v20, 0
    v_mov_b32 v21, 0
    s_sleep 10
    s_mov_b64 exec, s[52:53]
Lp_37:
    global_load_dwordx4 v[16:19], v4, s[30:31] sc1
    global_load_dwordx2 v[20:21], v5, s[30:31] offset:256 sc1
    global_load_dwordx4 v[24:27], v6, s[30:31] offset:384 sc1
Lc_39:
    s_waitcnt vmcnt(0)
    v_max3_u32 v8, v16, v17, v18
    v_max3_u32 v8, v8, v19, v20
    v_max_u32 v8, v8, v21
    v_cmp_eq_u32 vcc, -1, v8
    v_cmp_ne_u32 s[50:51], s32, v25
    s_or_b64 vcc, vcc, s[50:51]
    v_cmp_ne_u32 s[50:51], s32, v27
    s_or_b64 vcc, vcc, s[50:51]
    s_cbranch_vccz Ld_38
    s_add_u32 s33, s33, 1
    s_cmp_gt_u32 s33, 200000
    s_cbranch_scc1 Ld_38
    s_sleep 2
    s_branch Lp_37
Ld_38:
    s_mov_b64 exec, -1
    v_mov_b32 v25, v26
    ds_write_b128 v7, v[16:19] offset:37376
    ds_write_b64 v9, v[20:21] offset:37632
    ds_write_b64 v10, v[24:25] offset:5184
    v_mov_b32 v8, 1
    s_mov_b64 exec, 1
    ds_add_u32 v12, v8 offset:38920
    s_mov_b64 exec, -1
LA_l2:
    s_lshl_b32 s40, s3, 7
    v_and_b32 v4, 31, v1
    v_lshl_add_u32 v5, v4, 1, s40
    s_lshl_b32 s42, s3, 6
    v_lshl_add_u32 v7, v4, 1, s42
    v_lshl_add_u32 v4, v4, 2, s40
    v_mov_b32 v20, 0
    v_mov_b32 v21, 0
    v_mov_b32 v22, 0
    v_mov_b32 v23, 0
    v_and_b32 v6, 1, v2
    v_lshlrev_b32 v6, 6, v6
    v_lshl_add_u32 v6, v3, 4, v6
    v_add_u32 v6, s40, v6
    s_mul_i32 s40, s3, 768
    s_add_u32 s40, s40, 31744
    v_lshl_add_u32 v248, v2, 5, s40
    v_lshl_add_u32 v249, v2, 4, s40
    s_waitcnt vmcnt(0)
    v_lshlrev_b32 v232, 16, v232
    v_lshlrev_b32 v233, 16, v233
    v_lshlrev_b32 v234, 16, v234
    v_lshlrev_b32 v235, 16, v235
Lw_40:
    ds_read_b32 v8, v12 offset:38924
    s_waitcnt lgkmcnt(0)
    v_cmp_gt_u32 vcc, 3, v8
    s_cbranch_vccz Lwd_41
    s_add_u32 s33, s33, 1
    s_cmp_gt_u32 s33, 200000
    s_cbranch_scc1 Lwd_41
    s_sleep 1
    s_branch Lw_40
Lwd_41:
    ds_read_b32 v16, v4 offset:24576
    ds_read_b32 v17, v4 offset:25344
    ds_read_u16_d16_hi v20, v7 offset:37376
    ds_read_u16_d16_hi v21, v7 offset:37760
    ds_read_u16_d16_hi v22, v7 offset:38144
    ds_read_u16_d16_hi v23, v7 offset:38528
    ds_read_b128 v[24:27], v12 offset:5120
    ds_read_b128 v[28:31], v12 offset:5136
    ds_read_b64 v[32:33], v12 offset:5152
    s_waitcnt lgkmcnt(0)
    v_mul_f32 v16, v16, v32
    v_mul_f32 v24, v24, v232
    v_mul_f32 v28, v28, v20
    v_fmac_f32 v16, v17, v33
    v_fmac_f32 v24, v25, v233
    v_fmac_f32 v28, v29, v21
    v_fmac_f32 v24, v26, v234
    v_fmac_f32 v28, v30, v22
    v_fmac_f32 v24, v27, v235
    v_fmac_f32 v28, v31, v23
    v_add_f32 v24, v24, v28
    v_add_f32 v16, v16, v24
    v_cvt_pk_bf16_f32 v17, v16, v16
    ds_write_b16 v5, v17 offset:30720
    v_and_b32 v18, 0xffff0000, v17
    v_sub_f32 v18, v16, v18
    v_cvt_pk_bf16_f32 v18, v18, v18
    ds_write_b16 v5, v18 offset:30784
    s_waitcnt lgkmcnt(0)
    ds_read_b128 v[224:227], v6 offset:30720
    s_waitcnt lgkmcnt(0)
    v_mfma_f32_16x16x32_bf16 v[128:131], v[224:227], v[176:179], 0
    v_mfma_f32_16x16x32_bf16 v[132:135], v[224:227], v[180:183], 0
    v_mfma_f32_16x16x32_bf16 v[136:139], v[224:227], v[184:187], 0
    v_mfma_f32_16x16x32_bf16 v[140:143], v[224:227], v[188:191], 0
    v_mfma_f32_16x16x32_bf16 v[144:147], v[224:227], v[192:195], 0
    v_mfma_f32_16x16x32_bf16 v[148:151], v[224:227], v[196:199], 0
    v_mfma_f32_16x16x32_bf16 v[152:155], v[224:227], v[200:203], 0
    v_mfma_f32_16x16x32_bf16 v[156:159], v[224:227], v[204:207], 0
    v_mfma_f32_16x16x32_bf16 v[160:163], v[224:227], v[208:211], 0
    v_mfma_f32_16x16x32_bf16 v[164:167], v[224:227], v[212:215], 0
    v_mfma_f32_16x16x32_bf16 v[168:171], v[224:227], v[216:219], 0
    v_mfma_f32_16x16x32_bf16 v[172:175], v[224:227], v[220:223], 0
    v_add_f32 v16, v128, v129
    v_add_f32 v17, v132, v133
    v_add_f32 v18, v136, v137
    v_add_f32 v19, v140, v141
    v_add_f32 v20, v144, v145
    v_add_f32 v21, v148, v149
    v_add_f32 v22, v152, v153
    v_add_f32 v23, v156, v157
    v_add_f32 v24, v160, v161
    v_add_f32 v25, v164, v165
    v_add_f32 v26, v168, v169
    v_add_f32 v27, v172, v173
    s_mov_b32 exec_lo, 0xffff
    s_mov_b32 exec_hi, 0x0
    ds_write_b128 v248, v[16:19]
    ds_write_b128 v248, v[20:23] offset:16
    ds_write_b128 v249, v[24:27] offset:512
    s_mov_b64 exec, -1
LA_nov:
    v_lshlrev_b32 v4, 4, v1
    s_mul_i32 s40, s47, 3072
    s_lshl_b32 s42, s41, 8
    s_add_u32 s40, s40, s42
    s_add_u32 s40, s40, 950272
    v_lshlrev_b32 v5, 10, v3
    v_lshl_add_u32 v5, v2, 4, v5
    v_add_u32 v5, s40, v5
    s_waitcnt lgkmcnt(0)
    s_barrier
    s_cmp_eq_u32 s3, 0
    s_cbranch_scc0 Lfin
    ds_read_b128 v[16:19], v4 offset:31744
    ds_read_b128 v[20:23], v4 offset:32512
    ds_read_b128 v[24:27], v4 offset:33280
    ds_read_b128 v[28:31], v4 offset:34048
    ds_read_b128 v[32:35], v4 offset:34816
    ds_read_b128 v[36:39], v4 offset:35584
    s_waitcnt lgkmcnt(0)
    v_add_f32 v16, v16, v20
    v_add_f32 v17, v17, v21
    v_add_f32 v18, v18, v22
    v_add_f32 v19, v19, v23
    v_add_f32 v24, v24, v28
    v_add_f32 v25, v25, v29
    v_add_f32 v26, v26, v30
    v_add_f32 v27, v27, v31
    v_add_f32 v32, v32, v36
    v_add_f32 v33, v33, v37
    v_add_f32 v34, v34, v38
    v_add_f32 v35, v35, v39
    v_add_f32 v16, v16, v24
    v_add_f32 v17, v17, v25
    v_add_f32 v18, v18, v26
    v_add_f32 v19, v19, v27
    v_add_f32 v16, v16, v32
    v_add_f32 v17, v17, v33
    v_add_f32 v18, v18, v34
    v_add_f32 v19, v19, v35
    s_mov_b32 exec_lo, 0xffffffff
    s_mov_b32 exec_hi, 0xffff
    s_cmp_eq_u64 s[38:39], 0
    s_cbranch_scc0 Lsf_42
    global_store_dwordx4 v5, v[16:19], s[30:31]
    s_branch Lsd_43
Lsf_42:
    global_store_dwordx4 v5, v[16:19], s[30:31] sc1
Lsd_43:
    s_mov_b64 exec, -1
    s_add_u32 s40, s44, s3
    s_cmp_eq_u32 s40, 0
    s_cbranch_scc0 Lfin
    v_mov_b32 v5, s32
    global_store_dword v12, v5, s[30:31] sc1
    s_branch Lfin
LB2:
    s_mov_b32 s49, 0
    s_mul_i32 s54, s39, 10
    s_add_u32 s54, s54, s38
    s_add_u32 s40, s2, 0
    s_cmp_lt_u32 s38, 10
    s_cselect_b32 s54, s54, s40
    s_getreg_b32 s16, hwreg(HW_REG_XCC_ID, 0, 4)
    s_cmp_eq_u32 s3, 6
    s_cbranch_scc0 LB_not6
    s_lshr_b32 s50, s2, 3
    s_lshl_b32 s50, s50, 10
    v_lshlrev_b32 v24, 4, v1
    v_add_u32 v24, s50, v24
    v_min_u32 v24, CODE_LAST, v24
    global_load_dword v14, v24, s[36:37]
    v_add_u32 v24, 32768, v24
    v_min_u32 v24, CODE_LAST, v24
    global_load_dword v14, v24, s[36:37]
    s_mov_b32 s49, 1
LB_not6:
    s_cmp_eq_u32 s3, 7
    s_cbranch_scc0 LB_not7
    v_mov_b32 v28, -1
    v_mov_b32 v29, -1
    v_mov_b32 v30, -1
    v_mov_b32 v31, -1
    s_mul_i32 s50, s39, 2560
    s_lshl_b32 s51, s38, 8
    s_add_u32 s50, s50, s51
    s_add_u32 s50, s50, 1048576
    s_lshl_b32 s51, s54, 8
    s_add_u32 s51, s51, 1054720
    s_cmp_lt_u32 s54, 104
    s_cselect_b32 s50, s50, s51
    v_lshl_add_u32 v24, v2, 4, s50
    s_cmp_lt_u32 s54, 80
    s_cbranch_scc1 LB_c1
    s_cmp_lt_u32 s54, 104
    s_cbranch_scc0 LB_c1
    s_mul_i32 s50, s54, 2560
    s_add_u32 s50, s50, 909312
    v_lshl_add_u32 v24, v1, 4, s50
    global_store_dwordx4 v24, v[28:31], s[30:31] sc1
    global_store_dwordx4 v24, v[28:31], s[30:31] offset:1024 sc1
    v_and_b32 v24, 31, v1
    v_lshl_add_u32 v24, v24, 4, s50
    v_add_u32 v24, 2048, v24
LB_c1:
    global_store_dwordx4 v24, v[28:31], s[30:31] sc1
    s_mov_b32 s49, 1
LB_not7:
    s_lshl_b32 s46, s2, 6
    s_lshl_b32 s41, s3, 3
    s_add_u32 s46, s46, s41
    s_mul_i32 s46, s46, 1536
    s_and_b32 s47, s3, 1
    s_lshl_b32 s47, s47, 3
    s_mul_i32 s48, s3, 12288
    v_cmp_le_u32 vcc, 32, v1
    v_add_u32 v56, 64, v1
    v_subrev_u32 v57, 32, v1
    v_cndmask_b32 v56, v56, v57, vcc
    v_cndmask_b32 v58, 0, 1, vcc
    v_xor_b32 v56, v56, v58
    v_mul_u32_u24 v58, 1536, v58
    v_add_u32 v57, 32, v1
    v_xor_b32 v57, 1, v57
    v_mov_b32 v253, 142856
    ds_write_b32 v253, v12
    s_waitcnt lgkmcnt(0)
    s_barrier
    s_add_u32 s43, s47, 0
    v_xor_b32 v8, s43, v1
    s_add_u32 s44, s46, 0
    v_lshl_add_u32 v8, v8, 4, s44
    s_add_u32 m0, s48, 0
    s_nop 0
    global_load_lds_dwordx4 v8, s[6:7] nt
    s_add_u32 s43, s47, 0
    v_xor_b32 v8, s43, v56
    s_add_u32 s44, s46, 0
    v_lshl_add_u32 v8, v8, 4, v58
    v_add_u32 v8, s44, v8
    s_add_u32 m0, s48, 1024
    s_nop 0
    global_load_lds_dwordx4 v8, s[6:7] nt
    s_add_u32 s43, s47, 0
    v_xor_b32 v8, s43, v57
    s_add_u32 s44, s46, 1536
    v_lshl_add_u32 v8, v8, 4, s44
    s_add_u32 m0, s48, 2048
    s_nop 0
    global_load_lds_dwordx4 v8, s[6:7] nt
    s_add_u32 s43, s47, 2
    v_xor_b32 v8, s43, v1
    s_add_u32 s44, s46, 3072
    v_lshl_add_u32 v8, v8, 4, s44
    s_add_u32 m0, s48, 3072
    s_nop 0
    global_load_lds_dwordx4 v8, s[6:7] nt
    s_add_u32 s43, s47, 2
    v_xor_b32 v8, s43, v56
    s_add_u32 s44, s46, 3072
    v_lshl_add_u32 v8, v8, 4, v58
    v_add_u32 v8, s44, v8
    s_add_u32 m0, s48, 4096
    s_nop 0
    global_load_lds_dwordx4 v8, s[6:7] nt
    s_mov_b32 s34, 0x05040100
    s_mov_b32 s35, 0x07060302
    s_mov_b32 s33, 0
    s_mov_b32 s56, 0x3fb8aa3b
    s_mov_b32 s57, 0x32a57060
    s_mov_b32 s58, 0x3f317218
    s_mov_b32 s59, 0x3d93cd3a
    s_cmp_ge_u32 s2, 120
    s_cselect_b32 s49, 1, s49
    s_cmp_eq_u32 s49, 0
    s_cbranch_scc1 LB_w8
    s_waitcnt vmcnt(5)
LB_w8:
    s_waitcnt vmcnt(14)
    v_lshlrev_b32 v24, 16, v16
    v_and_b32 v25, 0xffff0000, v16
    v_lshlrev_b32 v26, 16, v17
    v_and_b32 v27, 0xffff0000, v17
    v_lshlrev_b32 v28, 16, v18
    v_and_b32 v29, 0xffff0000, v18
    v_lshlrev_b32 v30, 16, v19
    v_and_b32 v31, 0xffff0000, v19
    v_lshlrev_b32 v32, 16, v20
    v_and_b32 v33, 0xffff0000, v20
    v_add_f32 v22, v24, v25
    v_add_f32 v22, v22, v26
    v_add_f32 v22, v22, v27
    v_add_f32 v22, v22, v28
    v_add_f32 v22, v22, v29
    v_add_f32 v22, v22, v30
    v_add_f32 v22, v22, v31
    v_add_f32 v22, v22, v32
    v_add_f32 v22, v22, v33
    s_nop 1
    v_add_f32_dpp v22, v22, v22 row_ror:8 row_mask:0xf bank_mask:0xf
    s_nop 1
    v_add_f32_dpp v22, v22, v22 row_ror:4 row_mask:0xf bank_mask:0xf
    s_nop 1
    v_add_f32_dpp v22, v22, v22 row_ror:2 row_mask:0xf bank_mask:0xf
    s_nop 1
    v_add_f32_dpp v22, v22, v22 row_ror:1 row_mask:0xf bank_mask:0xf
    v_mov_b32 v23, v22
    s_nop 1
    v_permlane16_swap_b32 v22, v23
    v_add_f32 v22, v22, v23
    v_mov_b32 v23, v22
    s_nop 1
    v_permlane32_swap_b32 v22, v23
    v_add_f32 v22, v22, v23
    v_mul_f32 v22, 0x3acccccd, v22
    v_mov_b32 v23, 0
    v_sub_f32 v24, v24, v22
    v_fmac_f32 v23, v24, v24
    v_sub_f32 v25, v25, v22
    v_fmac_f32 v23, v25, v25
    v_sub_f32 v26, v26, v22
    v_fmac_f32 v23, v26, v26
    v_sub_f32 v27, v27, v22
    v_fmac_f32 v23, v27, v27
    v_sub_f32 v28, v28, v22
    v_fmac_f32 v23, v28, v28
    v_sub_f32 v29, v29, v22
    v_fmac_f32 v23, v29, v29
    v_sub_f32 v30, v30, v22
    v_fmac_f32 v23, v30, v30
    v_sub_f32 v31, v31, v22
    v_fmac_f32 v23, v31, v31
    v_sub_f32 v32, v32, v22
    v_fmac_f32 v23, v32, v32
    v_sub_f32 v33, v33, v22
    v_fmac_f32 v23, v33, v33
    s_nop 1
    v_add_f32_dpp v23, v23, v23 row_ror:8 row_mask:0xf bank_mask:0xf
    s_nop 1
    v_add_f32_dpp v23, v23, v23 row_ror:4 row_mask:0xf bank_mask:0xf
    s_nop 1
    v_add_f32_dpp v23, v23, v23 row_ror:2 row_mask:0xf bank_mask:0xf
    s_nop 1
    v_add_f32_dpp v23, v23, v23 row_ror:1 row_mask:0xf bank_mask:0xf
    v_mov_b32 v24, v23
    s_nop 1
    v_permlane16_swap_b32 v23, v24
    v_add_f32 v23, v23, v24
    v_mov_b32 v24, v23
    s_nop 1
    v_permlane32_swap_b32 v23, v24
    v_add_f32 v23, v23, v24
    v_mul_f32 v23, 0x3acccccd, v23
    v_cvt_pk_bf16_f32 v22, v22, v22
    v_and_b32 v22, 0xffff0000, v22
    v_cvt_pk_bf16_f32 v23, v23, v23
    v_and_b32 v23, 0xffff0000, v23
    v_add_f32 v23, 0x3727c5ac, v23
    v_cvt_pk_bf16_f32 v23, v23, v23
    v_and_b32 v23, 0xffff0000, v23
    v_sqrt_f32 v23, v23
    s_nop 0
    v_cvt_pk_bf16_f32 v23, v23, v23
    v_and_b32 v23, 0xffff0000, v23
    v_rcp_f32 v24, v23
    s_nop 0
    v_fma_f32 v25, -v23, v24, 1.0
    v_fma_f32 v24, v25, v24, v24
    v_lshlrev_b32 v21, 16, v21
    v_sub_f32 v21, v21, v22
    v_cvt_pk_bf16_f32 v21, v21, v21
    v_and_b32 v21, 0xffff0000, v21
    v_mul_f32 v20, v21, v24
    v_fma_f32 v25, -v23, v20, v21
    v_fma_f32 v20, v25, v24, v20
    v_cvt_pk_bf16_f32 v20, v20, v20
    v_and_b32 v20, 0xffff0000, v20
    s_cmp_lt_u32 s2, 120
    s_cbranch_scc0 LB_dma0
    s_lshl_b32 s40, s55, 14
    s_lshl_b32 s42, s3, 10
    s_add_u32 s40, s40, s42
    s_add_u32 s40, s40, 8192
    v_lshl_add_u32 v4, v1, 4, s40
    v_add_u32 v9, 8192, v4
    v_lshlrev_b32 v5, 1, v13
    v_add_u32 v5, 143360, v5
    s_lshl_b32 s40, s39, 4
    s_add_u32 s40, s40, 6144
    v_lshl_add_u32 v10, v2, 7, s40
    s_mul_i32 s40, s45, 43
    s_lshr_b32 s40, s40, 7
    s_mul_i32 s42, s40, 3
    s_sub_u32 s42, s45, s42
    s_lshl_b32 s42, s42, 9
    s_mul_i32 s40, s40, 15360
    s_add_u32 s40, s40, s42
    s_mul_i32 s42, s53, 1536
    s_add_u32 s40, s40, s42
    s_add_u32 s40, s40, 1179648
    v_and_b32 v6, 7, v2
    v_lshlrev_b32 v6, 5, v6
    v_lshrrev_b32 v7, 3, v2
    v_lshl_add_u32 v6, v7, 4, v6
    v_add_u32 v6, 0, v6
    v_lshlrev_b32 v6, 1, v6
    v_lshl_add_u32 v6, v3, 4, v6
    v_add_u32 v6, s40, v6
    v_cmp_eq_u32 s[42:43], 1, v3
    s_and_b32 s40, s3, 1
    s_lshl_b32 s40, s40, 7
    s_add_u32 s40, s40, 143360
    v_and_b32 v7, 1, v2
    v_lshlrev_b32 v7, 6, v7
    v_lshl_add_u32 v7, v3, 4, v7
    v_add_u32 v7, s40, v7
    s_waitcnt vmcnt(5)
    v_readfirstlane_b32 s32, v15
    s_mul_i32 s32, s32, 0x9E3779B1
    s_add_u32 s32, s32, 0x7F4A7C15
    v_mov_b32 v61, s32
    v_mov_b32 v63, s32
    global_load_dwordx4 v[16:19], v4, s[30:31] sc1
    global_load_dwordx4 v[24:27], v9, s[30:31] sc1
    global_load_dwordx2 v[28:29], v10, s[30:31] sc1
    v_perm_b32 v96, v68, v64, s34
    v_perm_b32 v97, v76, v72, s34
    v_perm_b32 v98, v84, v80, s34
    v_perm_b32 v99, v92, v88, s34
    v_perm_b32 v100, v68, v64, s35
    v_perm_b32 v101, v76, v72, s35
    v_perm_b32 v102, v84, v80, s35
    v_perm_b32 v103, v92, v88, s35
    v_perm_b32 v104, v69, v65, s34
    v_perm_b32 v105, v77, v73, s34
    v_perm_b32 v106, v85, v81, s34
    v_perm_b32 v107, v93, v89, s34
    v_perm_b32 v108, v69, v65, s35
    v_perm_b32 v109, v77, v73, s35
    v_perm_b32 v110, v85, v81, s35
    v_perm_b32 v111, v93, v89, s35
    v_perm_b32 v112, v70, v66, s34
    v_perm_b32 v113, v78, v74, s34
    v_perm_b32 v114, v86, v82, s34
    v_perm_b32 v115, v94, v90, s34
    v_perm_b32 v116, v70, v66, s35
    v_perm_b32 v117, v78, v74, s35
    v_perm_b32 v118, v86, v82, s35
    v_perm_b32 v119, v94, v90, s35
    v_perm_b32 v120, v71, v67, s34
    v_perm_b32 v121, v79, v75, s34
    v_perm_b32 v122, v87, v83, s34
    v_perm_b32 v123, v95, v91, s34
    v_perm_b32 v124, v71, v67, s35
    v_perm_b32 v125, v79, v75, s35
    v_perm_b32 v126, v87, v83, s35
    v_perm_b32 v127, v95, v91, s35
    s_branch Lc_46
Lp_44:
    global_load_dwordx4 v[16:19], v4, s[30:31] sc1
    global_load_dwordx4 v[24:27], v9, s[30:31] sc1
    global_load_dwordx2 v[28:29], v10, s[30:31] sc1
Lc_46:
    s_waitcnt vmcnt(0)
    v_cmp_ne_u32 vcc, s32, v17
    v_cmp_ne_u32 s[50:51], s32, v19
    s_or_b64 vcc, vcc, s[50:51]
    v_cmp_ne_u32 s[50:51], s32, v25
    s_or_b64 vcc, vcc, s[50:51]
    v_cmp_ne_u32 s[50:51], s32, v27
    s_or_b64 vcc, vcc, s[50:51]
    s_cbranch_vccz Ld_45
    s_add_u32 s33, s33, 1
    s_cmp_gt_u32 s33, 200000
    s_cbranch_scc1 Ld_45
    s_sleep 3
    s_branch Lp_44
Ld_45:
    s_setprio 3
    v_add_f32_dpp v16, v16, v16 row_ror:8 row_mask:0xf bank_mask:0xf
    v_add_f32_dpp v18, v18, v18 row_ror:8 row_mask:0xf bank_mask:0xf
    v_add_f32_dpp v24, v24, v24 row_ror:8 row_mask:0xf bank_mask:0xf
    v_add_f32_dpp v26, v26, v26 row_ror:8 row_mask:0xf bank_mask:0xf
    v_cmp_ne_u32 s[50:51], s16, v29
    v_cmp_ne_u32 vcc, s32, v28
    s_or_b64 s[50:51], s[50:51], vcc
    v_permlane16_swap_b32 v16, v18
    v_permlane16_swap_b32 v24, v26
    v_add_f32 v16, v16, v18
    v_add_f32 v24, v24, v26
    s_nop 1
    v_permlane32_swap_b32 v16, v24
    v_add_f32 v16, v16, v24
    v_mov_b32 v18, v16
    s_nop 1
    v_permlane16_swap_b32 v16, v18
    v_cvt_pk_bf16_f32 v16, v16, v16
    v_and_b32 v16, 0xffff0000, v16
    v_cvt_pk_bf16_f32 v18, v18, v18
    v_and_b32 v18, 0xffff0000, v18
    v_add_f32 v18, 1.0, v18
    v_cvt_pk_bf16_f32 v18, v18, v18
    v_and_b32 v18, 0xffff0000, v18
    v_mul_f32 v18, v20, v18
    v_cvt_pk_bf16_f32 v18, v18, v18
    v_and_b32 v18, 0xffff0000, v18
    v_add_f32 v16, v18, v16
    v_cvt_pk_bf16_f32 v16, v16, v16
    ds_write_b16 v5, v16
    s_waitcnt lgkmcnt(0)
    s_barrier
    ds_read_b128 v[16:19], v7
    s_waitcnt lgkmcnt(0)
    v_mfma_f32_16x16x32_bf16 v[24:27], v[16:19], v[96:99], 0
    v_mfma_f32_16x16x32_bf16 v[28:31], v[16:19], v[100:103], 0
    v_mfma_f32_16x16x32_bf16 v[32:35], v[16:19], v[104:107], 0
    v_mfma_f32_16x16x32_bf16 v[36:39], v[16:19], v[108:111], 0
    v_mfma_f32_16x16x32_bf16 v[40:43], v[16:19], v[112:115], 0
    v_mfma_f32_16x16x32_bf16 v[44:47], v[16:19], v[116:119], 0
    v_mfma_f32_16x16x32_bf16 v[48:51], v[16:19], v[120:123], 0
    v_mfma_f32_16x16x32_bf16 v[52:55], v[16:19], v[124:127], 0
    s_nop 0
    v_add_f32_dpp v8, v25, v24 row_ror:8 row_mask:0xf bank_mask:0x3
    v_add_f32_dpp v9, v29, v28 row_ror:8 row_mask:0xf bank_mask:0x3
    v_add_f32_dpp v10, v33, v32 row_ror:8 row_mask:0xf bank_mask:0x3
    v_add_f32_dpp v11, v37, v36 row_ror:8 row_mask:0xf bank_mask:0x3
    v_add_f32_dpp v8, v40, v41 row_ror:8 row_mask:0xf bank_mask:0xc
    v_add_f32_dpp v9, v44, v45 row_ror:8 row_mask:0xf bank_mask:0xc
    v_add_f32_dpp v10, v48, v49 row_ror:8 row_mask:0xf bank_mask:0xc
    v_add_f32_dpp v11, v52, v53 row_ror:8 row_mask:0xf bank_mask:0xc
    v_cndmask_b32 v60, v8, v10, s[42:43]
    v_cndmask_b32 v62, v9, v11, s[42:43]
    s_mov_b32 exec_lo, 0xffffffff
    s_mov_b32 exec_hi, 0x0
    s_cmp_eq_u64 s[50:51], 0
    s_cbranch_scc0 Lsf_47
    global_store_dwordx4 v6, v[60:63], s[30:31]
    s_branch Lsd_48
Lsf_47:
    global_store_dwordx4 v6, v[60:63], s[30:31] sc1
Lsd_48:
    s_mov_b64 exec, -1
    s_setprio 0
    s_barrier
    s_branch LB_dma
LB_dma0:
    v_readfirstlane_b32 s32, v15
    s_mul_i32 s32, s32, 0x9E3779B1
    s_add_u32 s32, s32, 0x7F4A7C15
LB_dma:
    s_cmp_eq_u32 s3, 7
    s_cbranch_scc0 LB_nrp
    s_getreg_b32 s51, hwreg(HW_REG_XCC_ID, 0, 4)
    s_waitcnt vmcnt(0)
    v_readfirstlane_b32 s32, v15
    s_mul_i32 s32, s32, 0x9E3779B1
    s_add_u32 s32, s32, 0x7F4A7C15
    s_lshl_b32 s40, s2, 4
    s_add_u32 s40, s40, 4096
    v_mov_b32 v4, s40
    v_mov_b32 v6, s32
    v_mov_b32 v7, s51
    s_mov_b32 exec_lo, 0x1
    s_mov_b32 exec_hi, 0x0
    global_store_dwordx2 v4, v[6:7], s[30:31] sc1
    s_mov_b64 exec, -1
LB_nrp:
    s_cmp_lt_u32 s3, 4
    s_cbranch_scc0 LB_qa
    s_add_u32 s43, s47, 2
    v_xor_b32 v8, s43, v57
    s_add_u32 s44, s46, 4608
    v_lshl_add_u32 v8, v8, 4, s44
    s_add_u32 m0, s48, 5120
    s_nop 0
    global_load_lds_dwordx4 v8, s[6:7] nt
    s_add_u32 s43, s47, 2
    v_xor_b32 v8, s43, v57
    s_add_u32 s44, s46, 53760
    v_lshl_add_u32 v8, v8, 4, s44
    s_add_u32 m0, s48, 54272
    s_nop 0
    global_load_lds_dwordx4 v8, s[6:7] nt
    s_add_u32 s43, s47, 4
    v_xor_b32 v8, s43, v1
    s_add_u32 s44, s46, 6144
    v_lshl_add_u32 v8, v8, 4, s44
    s_add_u32 m0, s48, 6144
    s_nop 0
    global_load_lds_dwordx4 v8, s[6:7] nt
    s_add_u32 s43, s47, 4
    v_xor_b32 v8, s43, v1
    s_add_u32 s44, s46, 55296
    v_lshl_add_u32 v8, v8, 4, s44
    s_add_u32 m0, s48, 55296
    s_nop 0
    global_load_lds_dwordx4 v8, s[6:7] nt
    s_add_u32 s43, s47, 4
    v_xor_b32 v8, s43, v56
    s_add_u32 s44, s46, 6144
    v_lshl_add_u32 v8, v8, 4, v58
    v_add_u32 v8, s44, v8
    s_add_u32 m0, s48, 7168
    s_nop 0
    global_load_lds_dwordx4 v8, s[6:7] nt
    s_add_u32 s43, s47, 4
    v_xor_b32 v8, s43, v56
    s_add_u32 s44, s46, 55296
    v_lshl_add_u32 v8, v8, 4, v58
    v_add_u32 v8, s44, v8
    s_add_u32 m0, s48, 56320
    s_nop 0
    global_load_lds_dwordx4 v8, s[6:7] nt
    s_add_u32 s43, s47, 4
    v_xor_b32 v8, s43, v57
    s_add_u32 s44, s46, 7680
    v_lshl_add_u32 v8, v8, 4, s44
    s_add_u32 m0, s48, 8192
    s_nop 0
    global_load_lds_dwordx4 v8, s[6:7] nt
    s_add_u32 s43, s47, 4
    v_xor_b32 v8, s43, v57
    s_add_u32 s44, s46, 56832
    v_lshl_add_u32 v8, v8, 4, s44
    s_add_u32 m0, s48, 57344
    s_nop 0
    global_load_lds_dwordx4 v8, s[6:7] nt
    s_add_u32 s43, s47, 6
    v_xor_b32 v8, s43, v1
    s_add_u32 s44, s46, 9216
    v_lshl_add_u32 v8, v8, 4, s44
    s_add_u32 m0, s48, 9216
    s_nop 0
    global_load_lds_dwordx4 v8, s[6:7] nt
    s_add_u32 s43, s47, 6
    v_xor_b32 v8, s43, v1
    s_add_u32 s44, s46, 58368
    v_lshl_add_u32 v8, v8, 4, s44
    s_add_u32 m0, s48, 58368
    s_nop 0
    global_load_lds_dwordx4 v8, s[6:7] nt
    s_add_u32 s43, s47, 6
    v_xor_b32 v8, s43, v56
    s_add_u32 s44, s46, 9216
    v_lshl_add_u32 v8, v8, 4, v58
    v_add_u32 v8, s44, v8
    s_add_u32 m0, s48, 10240
    s_nop 0
    global_load_lds_dwordx4 v8, s[6:7] nt
    s_add_u32 s43, s47, 6
    v_xor_b32 v8, s43, v56
    s_add_u32 s44, s46, 58368
    v_lshl_add_u32 v8, v8, 4, v58
    v_add_u32 v8, s44, v8
    s_add_u32 m0, s48, 59392
    s_nop 0
    global_load_lds_dwordx4 v8, s[6:7] nt
    s_add_u32 s43, s47, 6
    v_xor_b32 v8, s43, v57
    s_add_u32 s44, s46, 10752
    v_lshl_add_u32 v8, v8, 4, s44
    s_add_u32 m0, s48, 11264
    s_nop 0
    global_load_lds_dwordx4 v8, s[6:7] nt
    s_add_u32 s43, s47, 6
    v_xor_b32 v8, s43, v57
    s_add_u32 s44, s46, 59904
    v_lshl_add_u32 v8, v8, 4, s44
    s_add_u32 m0, s48, 60416
    s_nop 0
    global_load_lds_dwordx4 v8, s[6:7] nt
    v_lshrrev_b32 v4, 2, v2
    v_lshl_add_u32 v4, v3, 3, v4
    v_and_b32 v5, 3, v1
    s_mul_i32 s40, s3, 24
    v_add_u32 v5, s40, v5
    v_add_u32 v6, 0, v4
    v_and_b32 v7, 15, v6
    v_add_u32 v8, 0, v5
    v_xor_b32 v7, v7, v8
    v_mul_u32_u24 v6, 1536, v6
    v_lshl_add_u32 v40, v7, 4, v6
    v_add_u32 v6, 4, v4
    v_and_b32 v7, 15, v6
    v_add_u32 v8, 0, v5
    v_xor_b32 v7, v7, v8
    v_mul_u32_u24 v6, 1536, v6
    v_lshl_add_u32 v41, v7, 4, v6
    v_add_u32 v6, 0, v4
    v_and_b32 v7, 15, v6
    v_add_u32 v8, 4, v5
    v_xor_b32 v7, v7, v8
    v_mul_u32_u24 v6, 1536, v6
    v_lshl_add_u32 v42, v7, 4, v6
    v_add_u32 v6, 4, v4
    v_and_b32 v7, 15, v6
    v_add_u32 v8, 4, v5
    v_xor_b32 v7, v7, v8
    v_mul_u32_u24 v6, 1536, v6
    v_lshl_add_u32 v43, v7, 4, v6
    v_add_u32 v6, 0, v4
    v_and_b32 v7, 15, v6
    v_add_u32 v8, 8, v5
    v_xor_b32 v7, v7, v8
    v_mul_u32_u24 v6, 1536, v6
    v_lshl_add_u32 v44, v7, 4, v6
    v_add_u32 v6, 4, v4
    v_and_b32 v7, 15, v6
    v_add_u32 v8, 8, v5
    v_xor_b32 v7, v7, v8
    v_mul_u32_u24 v6, 1536, v6
    v_lshl_add_u32 v45, v7, 4, v6
    v_add_u32 v6, 0, v4
    v_and_b32 v7, 15, v6
    v_add_u32 v8, 12, v5
    v_xor_b32 v7, v7, v8
    v_mul_u32_u24 v6, 1536, v6
    v_lshl_add_u32 v46, v7, 4, v6
    v_add_u32 v6, 4, v4
    v_and_b32 v7, 15, v6
    v_add_u32 v8, 12, v5
    v_xor_b32 v7, v7, v8
    v_mul_u32_u24 v6, 1536, v6
    v_lshl_add_u32 v47, v7, 4, v6
    v_add_u32 v6, 0, v4
    v_and_b32 v7, 15, v6
    v_add_u32 v8, 16, v5
    v_xor_b32 v7, v7, v8
    v_mul_u32_u24 v6, 1536, v6
    v_lshl_add_u32 v48, v7, 4, v6
    v_add_u32 v6, 4, v4
    v_and_b32 v7, 15, v6
    v_add_u32 v8, 16, v5
    v_xor_b32 v7, v7, v8
    v_mul_u32_u24 v6, 1536, v6
    v_lshl_add_u32 v49, v7, 4, v6
    v_add_u32 v6, 0, v4
    v_and_b32 v7, 15, v6
    v_add_u32 v8, 20, v5
    v_xor_b32 v7, v7, v8
    v_mul_u32_u24 v6, 1536, v6
    v_lshl_add_u32 v50, v7, 4, v6
    v_add_u32 v6, 4, v4
    v_and_b32 v7, 15, v6
    v_add_u32 v8, 20, v5
    v_xor_b32 v7, v7, v8
    v_mul_u32_u24 v6, 1536, v6
    v_lshl_add_u32 v51, v7, 4, v6
    s_waitcnt vmcnt(0)
    v_mov_b32 v8, 1
    s_mov_b64 exec, 1
    ds_add_u32 v253, v8
    s_mov_b64 exec, -1
Lw_49:
    ds_read_b32 v8, v253 offset:0
    s_waitcnt lgkmcnt(0)
    v_cmp_gt_u32 vcc, 8, v8
    s_cbranch_vccz Lwd_50
    s_add_u32 s33, s33, 1
    s_cmp_gt_u32 s33, 200000
    s_cbranch_scc1 Lwd_50
    s_sleep 1
    s_branch Lw_49
Lwd_50:
    ds_read_b64_tr_b16 v[64:65], v40 offset:0
    ds_read_b64_tr_b16 v[68:69], v40 offset:49152
    ds_read_b64_tr_b16 v[72:73], v40 offset:8
    ds_read_b64_tr_b16 v[76:77], v40 offset:49160
    ds_read_b64_tr_b16 v[66:67], v41 offset:0
    ds_read_b64_tr_b16 v[70:71], v41 offset:49152
    ds_read_b64_tr_b16 v[74:75], v41 offset:8
    ds_read_b64_tr_b16 v[78:79], v41 offset:49160
    ds_read_b64_tr_b16 v[80:81], v42 offset:0
    ds_read_b64_tr_b16 v[84:85], v42 offset:49152
    ds_read_b64_tr_b16 v[88:89], v42 offset:8
    ds_read_b64_tr_b16 v[92:93], v42 offset:49160
    ds_read_b64_tr_b16 v[82:83], v43 offset:0
    ds_read_b64_tr_b16 v[86:87], v43 offset:49152
    ds_read_b64_tr_b16 v[90:91], v43 offset:8
    ds_read_b64_tr_b16 v[94:95], v43 offset:49160
    ds_read_b64_tr_b16 v[96:97], v44 offset:0
    ds_read_b64_tr_b16 v[100:101], v44 offset:49152
    ds_read_b64_tr_b16 v[104:105], v44 offset:8
    ds_read_b64_tr_b16 v[108:109], v44 offset:49160
    ds_read_b64_tr_b16 v[98:99], v45 offset:0
    ds_read_b64_tr_b16 v[102:103], v45 offset:49152
    ds_read_b64_tr_b16 v[106:107], v45 offset:8
    ds_read_b64_tr_b16 v[110:111], v45 offset:49160
    ds_read_b64_tr_b16 v[112:113], v46 offset:0
    ds_read_b64_tr_b16 v[116:117], v46 offset:49152
    ds_read_b64_tr_b16 v[120:121], v46 offset:8
    ds_read_b64_tr_b16 v[124:125], v46 offset:49160
    ds_read_b64_tr_b16 v[114:115], v47 offset:0
    ds_read_b64_tr_b16 v[118:119], v47 offset:49152
    ds_read_b64_tr_b16 v[122:123], v47 offset:8
    ds_read_b64_tr_b16 v[126:127], v47 offset:49160
    ds_read_b64_tr_b16 v[128:129], v48 offset:0
    ds_read_b64_tr_b16 v[132:133], v48 offset:49152
    ds_read_b64_tr_b16 v[136:137], v48 offset:8
    ds_read_b64_tr_b16 v[140:141], v48 offset:49160
    ds_read_b64_tr_b16 v[130:131], v49 offset:0
    ds_read_b64_tr_b16 v[134:135], v49 offset:49152
    ds_read_b64_tr_b16 v[138:139], v49 offset:8
    ds_read_b64_tr_b16 v[142:143], v49 offset:49160
    ds_read_b64_tr_b16 v[144:145], v50 offset:0
    ds_read_b64_tr_b16 v[148:149], v50 offset:49152
    ds_read_b64_tr_b16 v[152:153], v50 offset:8
    ds_read_b64_tr_b16 v[156:157], v50 offset:49160
    ds_read_b64_tr_b16 v[146:147], v51 offset:0
    ds_read_b64_tr_b16 v[150:151], v51 offset:49152
    ds_read_b64_tr_b16 v[154:155], v51 offset:8
    ds_read_b64_tr_b16 v[158:159], v51 offset:49160
    s_mul_i32 s41, s2, 384
    s_mul_i32 s40, s3, 49152
    s_add_u32 s41, s41, s40
    s_add_u32 s41, s41, 2097152
    s_mov_b32 s40, 196608
    v_lshrrev_b32 v61, 3, v1
    v_mul_lo_u32 v52, v61, s40
    v_and_b32 v8, 7, v1
    v_lshl_add_u32 v52, v8, 4, v52
    v_add_u32 v52, s41, v52
    s_mul_i32 s40, s3, 4608
    s_add_u32 s40, s40, 98304
    v_mul_u32_u24 v60, 144, v2
    v_lshl_add_u32 v60, v3, 4, v60
    v_add_u32 v60, s40, v60
    v_mul_u32_u24 v61, 144, v61
    v_lshl_add_u32 v61, v8, 4, v61
    v_add_u32 v61, s40, v61
    v_add_u32 v53, 1572864, v52
    v_add_u32 v54, 3145728, v52
    v_add_u32 v55, 4718592, v52
    s_lshl_b32 s40, s3, 11
    s_lshl_b32 s41, s2, 4
    s_add_u32 s40, s40, s41
    s_add_u32 s40, s40, 1703936
    v_lshl_add_u32 v56, v1, 13, s40
    v_and_b32 v57, 31, v1
    v_lshlrev_b32 v57, 4, v57
    v_add_u32 v57, 142336, v57
    s_branch LB_noqk
LB_qa:
    s_sub_u32 s45, s3, 4
    s_mul_i32 s40, s45, 24
    v_add_u32 v5, s40, v3
    v_mul_u32_u24 v4, 1536, v2
    v_add_u32 v6, 0, v5
    v_xor_b32 v6, v6, v2
    v_lshl_add_u32 v240, v6, 4, v4
    v_add_u32 v241, 49152, v240
    v_add_u32 v6, 4, v5
    v_xor_b32 v6, v6, v2
    v_lshl_add_u32 v242, v6, 4, v4
    v_add_u32 v243, 49152, v242
    v_add_u32 v6, 8, v5
    v_xor_b32 v6, v6, v2
    v_lshl_add_u32 v244, v6, 4, v4
    v_add_u32 v245, 49152, v244
    v_add_u32 v6, 12, v5
    v_xor_b32 v6, v6, v2
    v_lshl_add_u32 v246, v6, 4, v4
    v_add_u32 v247, 49152, v246
    v_add_u32 v6, 16, v5
    v_xor_b32 v6, v6, v2
    v_lshl_add_u32 v248, v6, 4, v4
    v_add_u32 v249, 49152, v248
    v_add_u32 v6, 20, v5
    v_xor_b32 v6, v6, v2
    v_lshl_add_u32 v250, v6, 4, v4
    v_add_u32 v251, 49152, v250
    s_mul_i32 s40, s45, 384
    s_add_u32 s40, s40, 360448
    v_lshrrev_b32 v8, 3, v1
    v_mul_u32_u24 v4, 1536, v8
    v_and_b32 v9, 7, v1
    v_xor_b32 v9, v9, v8
    v_lshl_add_u32 v4, v9, 4, v4
    v_add_u32 v4, s40, v4
    v_add_u32 v5, 12288, v4
    v_add_u32 v6, 24576, v4
    v_add_u32 v14, 36864, v4
    s_and_b32 s41, s2, 3
    s_mul_i32 s41, s41, 1536
    s_add_u32 s40, s40, s41
    s_add_u32 s40, s40, 320
    v_mul_u32_u24 v9, 6144, v1
    v_add_u32 v9, s40, v9
    s_mul_i32 s53, s45, 8704
    s_add_u32 s53, s53, 98304
    s_lshl_b32 s55, s45, 12
    s_add_u32 s41, s55, 135424
    s_add_u32 s55, s55, 124928
    s_cmp_lt_u32 s45, 2
    s_cselect_b32 s55, s55, s41
    v_and_b32 v8, 7, v2
    v_lshlrev_b32 v13, 7, v2
    v_xor_b32 v11, v3, v8
    v_lshl_add_u32 v11, v11, 4, v13
    v_xor_b32 v13, 64, v11
    v_add_u32 v15, s55, v13
    v_add_u32 v13, s53, v13
    v_add_u32 v160, s55, v11
    v_add_u32 v11, s53, v11
    s_mul_i32 s40, s45, 8704
    s_add_u32 s40, s40, 98304
    v_mul_u32_u24 v7, 272, v2
    v_lshl_add_u32 v7, v3, 4, v7
    v_add_u32 v7, s40, v7
    s_mov_b32 s52, 0
    s_waitcnt vmcnt(0)
    v_mov_b32 v8, 1
    s_mov_b64 exec, 1
    ds_add_u32 v253, v8
    s_mov_b64 exec, -1
    v_lshlrev_b32 v18, 4, v1
    v_add_u32 v18, 6144, v18
Lp_51:
    global_load_dword v16, v18, s[30:31] offset:0 sc1
    global_load_dword v17, v18, s[30:31] offset:1024 sc1
Lc_53:
    s_waitcnt vmcnt(0)
    v_cmp_ne_u32 vcc, s32, v16
    v_cmp_ne_u32 s[50:51], s32, v17
    s_or_b64 vcc, vcc, s[50:51]
    s_cbranch_vccz Ld_52
    s_add_u32 s33, s33, 1
    s_cmp_gt_u32 s33, 200000
    s_cbranch_scc1 Ld_52
    s_sleep 4
    s_branch Lp_51
Ld_52:
    v_mov_b32 v10, 0
LB_q0:
    s_mov_b64 exec, 3
    global_load_dword v10, v9, s[30:31] sc1
    s_mov_b64 exec, -1
    s_cmp_eq_u32 s52, 0
    s_cbranch_scc0 LB_q1
    ds_read_b32 v8, v253
    s_waitcnt lgkmcnt(0)
    v_cmp_gt_u32 vcc, 8, v8
    s_cbranch_vccnz LB_q1
    s_mov_b32 s52, 1
    ds_read_b128 v[64:67], v240 offset:0
    ds_read_b128 v[68:71], v242 offset:0
    ds_read_b128 v[72:75], v244 offset:0
    ds_read_b128 v[76:79], v246 offset:0
    ds_read_b128 v[80:83], v248 offset:0
    ds_read_b128 v[84:87], v250 offset:0
    ds_read_b128 v[88:91], v240 offset:24576
    ds_read_b128 v[92:95], v242 offset:24576
    ds_read_b128 v[96:99], v244 offset:24576
    ds_read_b128 v[100:103], v246 offset:24576
    ds_read_b128 v[104:107], v248 offset:24576
    ds_read_b128 v[108:111], v250 offset:24576
    ds_read_b128 v[112:115], v241 offset:0
    ds_read_b128 v[116:119], v243 offset:0
    ds_read_b128 v[120:123], v245 offset:0
    ds_read_b128 v[124:127], v247 offset:0
    ds_read_b128 v[128:131], v249 offset:0
    ds_read_b128 v[132:135], v251 offset:0
    ds_read_b128 v[136:139], v241 offset:24576
    ds_read_b128 v[140:143], v243 offset:24576
    ds_read_b128 v[144:147], v245 offset:24576
    ds_read_b128 v[148:151], v247 offset:24576
    ds_read_b128 v[152:155], v249 offset:24576
    ds_read_b128 v[156:159], v251 offset:24576
LB_q1:
    s_waitcnt vmcnt(0)
    v_cmp_eq_u32 vcc, -1, v10
    s_cbranch_vccz LB_h2go
    s_add_u32 s33, s33, 1
    s_cmp_gt_u32 s33, 200000
    s_cbranch_scc1 LB_h2go
    s_sleep 1
    s_branch LB_q0
LB_h2go:
    s_add_u32 m0, s53, 0
    s_nop 0
    global_load_lds_dwordx4 v4, s[30:31] offset:0 sc1
    s_add_u32 m0, s53, 1024
    s_nop 0
    global_load_lds_dwordx4 v5, s[30:31] offset:0 sc1
    s_add_u32 m0, s53, 2048
    s_nop 0
    global_load_lds_dwordx4 v6, s[30:31] offset:0 sc1
    s_add_u32 m0, s53, 3072
    s_nop 0
    global_load_lds_dwordx4 v14, s[30:31] offset:0 sc1
    s_add_u32 m0, s53, 3968
    s_nop 0
    global_load_lds_dwordx4 v4, s[30:31] offset:128 sc1
    s_add_u32 m0, s53, 4992
    s_nop 0
    global_load_lds_dwordx4 v5, s[30:31] offset:128 sc1
    s_add_u32 m0, s53, 6016
    s_nop 0
    global_load_lds_dwordx4 v6, s[30:31] offset:128 sc1
    s_add_u32 m0, s53, 7040
    s_nop 0
    global_load_lds_dwordx4 v14, s[30:31] offset:128 sc1
    s_add_u32 m0, s55, 7936
    s_nop 0
    global_load_lds_dwordx4 v4, s[30:31] offset:256 sc1
    s_add_u32 m0, s55, 8960
    s_nop 0
    global_load_lds_dwordx4 v5, s[30:31] offset:256 sc1
    s_add_u32 m0, s55, 9984
    s_nop 0
    global_load_lds_dwordx4 v6, s[30:31] offset:256 sc1
    s_add_u32 m0, s55, 11008
    s_nop 0
    global_load_lds_dwordx4 v14, s[30:31] offset:256 sc1
    s_cmp_eq_u32 s52, 0
    s_cbranch_scc0 LB_q2
Lw_54:
    ds_read_b32 v8, v253 offset:0
    s_waitcnt lgkmcnt(0)
    v_cmp_gt_u32 vcc, 8, v8
    s_cbranch_vccz Lwd_55
    s_add_u32 s33, s33, 1
    s_cmp_gt_u32 s33, 200000
    s_cbranch_scc1 Lwd_55
    s_sleep 1
    s_branch Lw_54
Lwd_55:
    ds_read_b128 v[64:67], v240 offset:0
    ds_read_b128 v[68:71], v242 offset:0
    ds_read_b128 v[72:75], v244 offset:0
    ds_read_b128 v[76:79], v246 offset:0
    ds_read_b128 v[80:83], v248 offset:0
    ds_read_b128 v[84:87], v250 offset:0
    ds_read_b128 v[88:91], v240 offset:24576
    ds_read_b128 v[92:95], v242 offset:24576
    ds_read_b128 v[96:99], v244 offset:24576
    ds_read_b128 v[100:103], v246 offset:24576
    ds_read_b128 v[104:107], v248 offset:24576
    ds_read_b128 v[108:111], v250 offset:24576
    ds_read_b128 v[112:115], v241 offset:0
    ds_read_b128 v[116:119], v243 offset:0
    ds_read_b128 v[120:123], v245 offset:0
    ds_read_b128 v[124:127], v247 offset:0
    ds_read_b128 v[128:131], v249 offset:0
    ds_read_b128 v[132:135], v251 offset:0
    ds_read_b128 v[136:139], v241 offset:24576
    ds_read_b128 v[140:143], v243 offset:24576
    ds_read_b128 v[144:147], v245 offset:24576
    ds_read_b128 v[148:151], v247 offset:24576
    ds_read_b128 v[152:155], v249 offset:24576
    ds_read_b128 v[156:159], v251 offset:24576
LB_q2:
    s_setprio 3
    s_branch LB_qm
LB_qr:
    s_add_u32 m0, s53, 0
    s_nop 0
    global_load_lds_dwordx4 v4, s[30:31] offset:0 sc1
    s_add_u32 m0, s53, 1024
    s_nop 0
    global_load_lds_dwordx4 v5, s[30:31] offset:0 sc1
    s_add_u32 m0, s53, 2048
    s_nop 0
    global_load_lds_dwordx4 v6, s[30:31] offset:0 sc1
    s_add_u32 m0, s53, 3072
    s_nop 0
    global_load_lds_dwordx4 v14, s[30:31] offset:0 sc1
    s_add_u32 m0, s53, 3968
    s_nop 0
    global_load_lds_dwordx4 v4, s[30:31] offset:128 sc1
    s_add_u32 m0, s53, 4992
    s_nop 0
    global_load_lds_dwordx4 v5, s[30:31] offset:128 sc1
    s_add_u32 m0, s53, 6016
    s_nop 0
    global_load_lds_dwordx4 v6, s[30:31] offset:128 sc1
    s_add_u32 m0, s53, 7040
    s_nop 0
    global_load_lds_dwordx4 v14, s[30:31] offset:128 sc1
    s_add_u32 m0, s55, 7936
    s_nop 0
    global_load_lds_dwordx4 v4, s[30:31] offset:256 sc1
    s_add_u32 m0, s55, 8960
    s_nop 0
    global_load_lds_dwordx4 v5, s[30:31] offset:256 sc1
    s_add_u32 m0, s55, 9984
    s_nop 0
    global_load_lds_dwordx4 v6, s[30:31] offset:256 sc1
    s_add_u32 m0, s55, 11008
    s_nop 0
    global_load_lds_dwordx4 v14, s[30:31] offset:256 sc1
LB_qm:
    s_waitcnt vmcnt(8)
    ds_read_b128 v[16:19], v11 offset:0
    ds_read_b128 v[20:23], v11 offset:2048
    ds_read_b128 v[24:27], v13 offset:0
    ds_read_b128 v[28:31], v13 offset:2048
    s_waitcnt vmcnt(4)
    ds_read_b128 v[32:35], v11 offset:4096
    ds_read_b128 v[36:39], v11 offset:6144
    ds_read_b128 v[40:43], v13 offset:4096
    ds_read_b128 v[44:47], v13 offset:6144
    s_waitcnt lgkmcnt(4)
    s_nop 0
    v_mfma_f32_16x16x32_bf16 v[224:227], v[64:67], v[16:19], 0
    v_max_u32 v8, v16, v17
    v_mfma_f32_16x16x32_bf16 v[228:231], v[64:67], v[20:23], 0
    v_max3_u32 v8, v8, v18, v19
    v_mfma_f32_16x16x32_bf16 v[232:235], v[88:91], v[16:19], 0
    v_max3_u32 v8, v8, v20, v21
    v_mfma_f32_16x16x32_bf16 v[236:239], v[88:91], v[20:23], 0
    v_max3_u32 v8, v8, v22, v23
    v_mfma_f32_16x16x32_bf16 v[240:243], v[112:115], v[16:19], 0
    v_mfma_f32_16x16x32_bf16 v[244:247], v[112:115], v[20:23], 0
    v_mfma_f32_16x16x32_bf16 v[248:251], v[136:139], v[16:19], 0
    v_mfma_f32_16x16x32_bf16 v[252:255], v[136:139], v[20:23], 0
    v_mfma_f32_16x16x32_bf16 v[224:227], v[68:71], v[24:27], v[224:227]
    v_max3_u32 v8, v8, v24, v25
    v_mfma_f32_16x16x32_bf16 v[228:231], v[68:71], v[28:31], v[228:231]
    v_max3_u32 v8, v8, v26, v27
    v_mfma_f32_16x16x32_bf16 v[232:235], v[92:95], v[24:27], v[232:235]
    v_max3_u32 v8, v8, v28, v29
    v_mfma_f32_16x16x32_bf16 v[236:239], v[92:95], v[28:31], v[236:239]
    v_max3_u32 v8, v8, v30, v31
    v_mfma_f32_16x16x32_bf16 v[240:243], v[116:119], v[24:27], v[240:243]
    v_mfma_f32_16x16x32_bf16 v[244:247], v[116:119], v[28:31], v[244:247]
    v_mfma_f32_16x16x32_bf16 v[248:251], v[140:143], v[24:27], v[248:251]
    v_mfma_f32_16x16x32_bf16 v[252:255], v[140:143], v[28:31], v[252:255]
    s_waitcnt vmcnt(0)
    ds_read_b128 v[48:51], v160 offset:8192
    ds_read_b128 v[52:55], v160 offset:10240
    ds_read_b128 v[56:59], v15 offset:8192
    ds_read_b128 v[60:63], v15 offset:10240
    s_waitcnt lgkmcnt(4)
    v_mfma_f32_16x16x32_bf16 v[224:227], v[72:75], v[32:35], v[224:227]
    v_max3_u32 v8, v8, v32, v33
    v_mfma_f32_16x16x32_bf16 v[228:231], v[72:75], v[36:39], v[228:231]
    v_max3_u32 v8, v8, v34, v35
    v_mfma_f32_16x16x32_bf16 v[232:235], v[96:99], v[32:35], v[232:235]
    v_max3_u32 v8, v8, v36, v37
    v_mfma_f32_16x16x32_bf16 v[236:239], v[96:99], v[36:39], v[236:239]
    v_max3_u32 v8, v8, v38, v39
    v_mfma_f32_16x16x32_bf16 v[240:243], v[120:123], v[32:35], v[240:243]
    v_mfma_f32_16x16x32_bf16 v[244:247], v[120:123], v[36:39], v[244:247]
    v_mfma_f32_16x16x32_bf16 v[248:251], v[144:147], v[32:35], v[248:251]
    v_mfma_f32_16x16x32_bf16 v[252:255], v[144:147], v[36:39], v[252:255]
    v_mfma_f32_16x16x32_bf16 v[224:227], v[76:79], v[40:43], v[224:227]
    v_max3_u32 v8, v8, v40, v41
    v_mfma_f32_16x16x32_bf16 v[228:231], v[76:79], v[44:47], v[228:231]
    v_max3_u32 v8, v8, v42, v43
    v_mfma_f32_16x16x32_bf16 v[232:235], v[100:103], v[40:43], v[232:235]
    v_max3_u32 v8, v8, v44, v45
    v_mfma_f32_16x16x32_bf16 v[236:239], v[100:103], v[44:47], v[236:239]
    v_max3_u32 v8, v8, v46, v47
    v_mfma_f32_16x16x32_bf16 v[240:243], v[124:127], v[40:43], v[240:243]
    v_mfma_f32_16x16x32_bf16 v[244:247], v[124:127], v[44:47], v[244:247]
    v_mfma_f32_16x16x32_bf16 v[248:251], v[148:151], v[40:43], v[248:251]
    v_mfma_f32_16x16x32_bf16 v[252:255], v[148:151], v[44:47], v[252:255]
    s_waitcnt lgkmcnt(0)
    v_mfma_f32_16x16x32_bf16 v[224:227], v[80:83], v[48:51], v[224:227]
    v_max3_u32 v8, v8, v48, v49
    v_mfma_f32_16x16x32_bf16 v[228:231], v[80:83], v[52:55], v[228:231]
    v_max3_u32 v8, v8, v50, v51
    v_mfma_f32_16x16x32_bf16 v[232:235], v[104:107], v[48:51], v[232:235]
    v_max3_u32 v8, v8, v52, v53
    v_mfma_f32_16x16x32_bf16 v[236:239], v[104:107], v[52:55], v[236:239]
    v_max3_u32 v8, v8, v54, v55
    v_mfma_f32_16x16x32_bf16 v[240:243], v[128:131], v[48:51], v[240:243]
    v_mfma_f32_16x16x32_bf16 v[244:247], v[128:131], v[52:55], v[244:247]
    v_mfma_f32_16x16x32_bf16 v[248:251], v[152:155], v[48:51], v[248:251]
    v_mfma_f32_16x16x32_bf16 v[252:255], v[152:155], v[52:55], v[252:255]
    v_mfma_f32_16x16x32_bf16 v[224:227], v[84:87], v[56:59], v[224:227]
    v_max3_u32 v8, v8, v56, v57
    v_mfma_f32_16x16x32_bf16 v[228:231], v[84:87], v[60:63], v[228:231]
    v_max3_u32 v8, v8, v58, v59
    v_mfma_f32_16x16x32_bf16 v[232:235], v[108:111], v[56:59], v[232:235]
    v_max3_u32 v8, v8, v60, v61
    v_mfma_f32_16x16x32_bf16 v[236:239], v[108:111], v[60:63], v[236:239]
    v_max3_u32 v8, v8, v62, v63
    v_mfma_f32_16x16x32_bf16 v[240:243], v[132:135], v[56:59], v[240:243]
    v_mfma_f32_16x16x32_bf16 v[244:247], v[132:135], v[60:63], v[244:247]
    v_mfma_f32_16x16x32_bf16 v[248:251], v[156:159], v[56:59], v[248:251]
    v_mfma_f32_16x16x32_bf16 v[252:255], v[156:159], v[60:63], v[252:255]
    v_cmp_eq_u32 vcc, -1, v8
    s_cbranch_vccz LB_qd
    s_add_u32 s33, s33, 1
    s_cmp_gt_u32 s33, 200000
    s_cbranch_scc1 LB_qd
    s_sleep 1
    s_branch LB_qr
LB_qd:
    ds_write_b128 v7, v[224:227] offset:0
    ds_write_b128 v7, v[228:231] offset:4352
    ds_write_b128 v7, v[232:235] offset:64
    ds_write_b128 v7, v[236:239] offset:4416
    ds_write_b128 v7, v[240:243] offset:128
    ds_write_b128 v7, v[244:247] offset:4480
    ds_write_b128 v7, v[248:251] offset:192
    ds_write_b128 v7, v[252:255] offset:4544
LB_noqk:
    s_lshl_b32 s40, s3, 2
    v_add_u32 v9, s40, v3
    v_mul_u32_u24 v4, 272, v9
    v_lshl_add_u32 v4, v2, 4, v4
    v_add_u32 v4, 98304, v4
    v_mul_u32_u24 v5, 144, v9
    v_lshl_add_u32 v5, v2, 3, v5
    v_add_u32 v5, 133120, v5
    s_lshl_b32 s40, s2, 4
    s_add_u32 s40, s40, 425984
    v_lshl_add_u32 v6, v9, 11, s40
    v_lshlrev_b32 v7, 4, v9
    v_add_u32 v7, 142336, v7
    v_lshlrev_b32 v10, 2, v2
    v_mov_b32 v45, s32
    v_mov_b32 v47, s32
    s_lshl_b32 s40, s2, 7
    s_add_u32 s40, s40, 1966080
    v_mov_b32 v8, s40
    v_cmp_eq_u32 vcc, 1, v1
    s_nop 1
    v_cndmask_b32 v6, v6, v8, vcc
    s_cmp_eq_u32 s3, 7
    s_cselect_b32 s49, 2, 0
    s_or_b32 s49, s49, 0x00010001
    v_mov_b32 v58, 142848
    v_mov_b32 v13, 0
    ds_write_b64 v58, v[12:13]
    ds_write_b32 v58, v12 offset:12
    ds_write_b32 v58, v12 offset:16
    ds_write_b32 v58, v12 offset:20
    v_add_u32 v40, 0, v10
    v_add_u32 v41, 1, v10
    v_add_u32 v42, 2, v10
    v_add_u32 v43, 3, v10
    s_waitcnt lgkmcnt(0)
    s_barrier
    s_setprio 3
    ds_read_b128 v[16:19], v4 offset:0
    ds_read_b128 v[20:23], v4 offset:8704
    ds_read_b128 v[24:27], v4 offset:17408
    ds_read_b128 v[28:31], v4 offset:26112
    v_mul_u32_u24 v4, 144, v2
    v_lshl_add_u32 v4, v3, 4, v4
    v_add_u32 v4, 133120, v4
    v_mov_b32 v11, 0xff800000
    s_mov_b32 s40, 0xffffffc0
    s_waitcnt lgkmcnt(0)
    v_pk_add_f32 v[16:17], v[16:17], v[20:21]
    v_pk_add_f32 v[24:25], v[24:25], v[28:29]
    v_pk_add_f32 v[18:19], v[18:19], v[22:23]
    v_pk_add_f32 v[26:27], v[26:27], v[30:31]
    v_pk_add_f32 v[32:33], v[16:17], v[24:25]
    v_pk_add_f32 v[34:35], v[18:19], v[26:27]
    v_and_or_b32 v36, v32, s40, v40
    v_and_or_b32 v37, v33, s40, v41
    v_and_or_b32 v38, v34, s40, v42
    v_and_or_b32 v39, v35, s40, v43
    v_max3_f32 v50, v36, v37, v38
    v_max_f32 v50, v50, v39
    v_cvt_pk_bf16_f32 v16, v36, v37
    v_cvt_pk_bf16_f32 v17, v38, v39
    v_max_f32_dpp v50, v50, v50 row_ror:8 row_mask:0xf bank_mask:0xf
    v_lshlrev_b32 v32, 16, v16
    v_and_b32 v33, 0xffff0000, v16
    v_max_f32_dpp v50, v50, v50 row_ror:4 row_mask:0xf bank_mask:0xf
    v_lshlrev_b32 v34, 16, v17
    v_and_b32 v35, 0xffff0000, v17
    v_max_f32_dpp v50, v50, v50 row_ror:2 row_mask:0xf bank_mask:0xf
    v_mul_f32 v32, s59, v32
    v_mul_f32 v33, s59, v33
    v_max_f32_dpp v50, v50, v50 row_ror:1 row_mask:0xf bank_mask:0xf
    v_mul_f32 v34, s59, v34
    v_mul_f32 v35, s59, v35
    v_cmp_eq_u32 s[50:51], v36, v50
    v_cvt_pk_bf16_f32 v62, v50, v50
    v_cmp_eq_u32 s[52:53], v37, v50
    v_cndmask_b32 v36, v36, v11, s[50:51]
    v_cmp_eq_u32 s[50:51], v38, v50
    v_cndmask_b32 v37, v37, v11, s[52:53]
    v_cmp_eq_u32 s[52:53], v39, v50
    v_cndmask_b32 v38, v38, v11, s[50:51]
    v_cvt_pk_bf16_f32 v16, v32, v33
    v_cndmask_b32 v39, v39, v11, s[52:53]
    v_and_b32 v62, 0xffff0000, v62
    v_max3_f32 v51, v36, v37, v38
    v_cvt_pk_bf16_f32 v17, v34, v35
    v_max_f32 v51, v51, v39
    v_mul_f32 v62, s59, v62
    v_lshlrev_b32 v32, 16, v16
    v_max_f32_dpp v51, v51, v51 row_ror:8 row_mask:0xf bank_mask:0xf
    v_cvt_pk_bf16_f32 v62, v62, v62
    v_and_b32 v33, 0xffff0000, v16
    v_max_f32_dpp v51, v51, v51 row_ror:4 row_mask:0xf bank_mask:0xf
    v_and_b32 v62, 0xffff0000, v62
    v_lshlrev_b32 v34, 16, v17
    v_max_f32_dpp v51, v51, v51 row_ror:2 row_mask:0xf bank_mask:0xf
    v_and_b32 v35, 0xffff0000, v17
    v_and_or_b32 v44, v50, 63, v62
    v_max_f32_dpp v51, v51, v51 row_ror:1 row_mask:0xf bank_mask:0xf
    v_sub_f32 v24, v32, v62
    v_sub_f32 v25, v33, v62
    v_cvt_pk_bf16_f32 v18, v51, v51
    v_sub_f32 v26, v34, v62
    v_and_b32 v18, 0xffff0000, v18
    v_sub_f32 v27, v35, v62
    v_mul_f32 v18, s59, v18
    v_mul_f32 v24, s56, v24
    v_cvt_pk_bf16_f32 v18, v18, v18
    v_mul_f32 v25, s56, v25
    v_and_b32 v18, 0xffff0000, v18
    v_mul_f32 v26, s56, v26
    v_and_or_b32 v46, v51, 63, v18
    s_mov_b32 exec_lo, s49
    s_mov_b32 exec_hi, 0x00010001
    global_store_dwordx4 v6, v[44:47], s[30:31] sc1
    s_mov_b64 exec, -1
    v_mul_f32 v27, s56, v27
    v_exp_f32 v24, v24
    v_exp_f32 v25, v25
    v_exp_f32 v26, v26
    v_exp_f32 v27, v27
    v_cvt_pk_bf16_f32 v36, v24, v25
    v_cvt_pk_bf16_f32 v37, v26, v27
    ds_write_b64 v5, v[36:37]
    v_add_f32 v49, v24, v25
    v_add_f32 v48, v26, v27
    v_add_f32 v49, v49, v48
    s_waitcnt lgkmcnt(0)
    s_barrier
    s_cmp_lt_u32 s3, 4
    s_cbranch_scc0 LB_lw
    ds_read_b128 v[16:19], v4 offset:0
    ds_read_b128 v[20:23], v4 offset:64
    ds_read_b128 v[24:27], v4 offset:2304
    ds_read_b128 v[28:31], v4 offset:2368
    s_waitcnt lgkmcnt(0)
    v_mfma_f32_16x16x32_bf16 v[160:163], v[64:67], v[16:19], 0
    v_mfma_f32_16x16x32_bf16 v[160:163], v[68:71], v[20:23], v[160:163]
    v_mfma_f32_16x16x32_bf16 v[164:167], v[72:75], v[16:19], 0
    v_mfma_f32_16x16x32_bf16 v[164:167], v[76:79], v[20:23], v[164:167]
    v_mfma_f32_16x16x32_bf16 v[168:171], v[80:83], v[16:19], 0
    v_mfma_f32_16x16x32_bf16 v[168:171], v[84:87], v[20:23], v[168:171]
    v_mfma_f32_16x16x32_bf16 v[172:175], v[88:91], v[16:19], 0
    v_mfma_f32_16x16x32_bf16 v[172:175], v[92:95], v[20:23], v[172:175]
    v_mfma_f32_16x16x32_bf16 v[176:179], v[64:67], v[24:27], 0
    v_mfma_f32_16x16x32_bf16 v[176:179], v[68:71], v[28:31], v[176:179]
    v_mfma_f32_16x16x32_bf16 v[180:183], v[72:75], v[24:27], 0
    v_mfma_f32_16x16x32_bf16 v[180:183], v[76:79], v[28:31], v[180:183]
    v_mfma_f32_16x16x32_bf16 v[184:187], v[80:83], v[24:27], 0
    v_mfma_f32_16x16x32_bf16 v[184:187], v[84:87], v[28:31], v[184:187]
    v_mfma_f32_16x16x32_bf16 v[188:191], v[88:91], v[24:27], 0
    v_mfma_f32_16x16x32_bf16 v[188:191], v[92:95], v[28:31], v[188:191]
    v_cvt_pk_bf16_f32 v208, v160, v161
    v_cvt_pk_bf16_f32 v209, v162, v163
    v_cvt_pk_bf16_f32 v210, v164, v165
    v_cvt_pk_bf16_f32 v211, v166, v167
    v_cvt_pk_bf16_f32 v212, v168, v169
    v_cvt_pk_bf16_f32 v213, v170, v171
    v_cvt_pk_bf16_f32 v214, v172, v173
    v_cvt_pk_bf16_f32 v215, v174, v175
    ds_write_b128 v60, v[208:211] offset:0
    ds_write_b128 v60, v[212:215] offset:64
    ds_read_b128 v[224:227], v61 offset:0
    ds_read_b128 v[228:231], v61 offset:1152
    v_mfma_f32_16x16x32_bf16 v[192:195], v[96:99], v[16:19], 0
    v_mfma_f32_16x16x32_bf16 v[192:195], v[100:103], v[20:23], v[192:195]
    v_mfma_f32_16x16x32_bf16 v[196:199], v[104:107], v[16:19], 0
    v_mfma_f32_16x16x32_bf16 v[196:199], v[108:111], v[20:23], v[196:199]
    v_mfma_f32_16x16x32_bf16 v[200:203], v[112:115], v[16:19], 0
    v_mfma_f32_16x16x32_bf16 v[200:203], v[116:119], v[20:23], v[200:203]
    v_mfma_f32_16x16x32_bf16 v[204:207], v[120:123], v[16:19], 0
    v_mfma_f32_16x16x32_bf16 v[204:207], v[124:127], v[20:23], v[204:207]
    v_cvt_pk_bf16_f32 v216, v176, v177
    v_cvt_pk_bf16_f32 v217, v178, v179
    v_cvt_pk_bf16_f32 v218, v180, v181
    v_cvt_pk_bf16_f32 v219, v182, v183
    v_cvt_pk_bf16_f32 v220, v184, v185
    v_cvt_pk_bf16_f32 v221, v186, v187
    v_cvt_pk_bf16_f32 v222, v188, v189
    v_cvt_pk_bf16_f32 v223, v190, v191
    ds_write_b128 v60, v[216:219] offset:2304
    ds_write_b128 v60, v[220:223] offset:2368
    ds_read_b128 v[232:235], v61 offset:2304
    ds_read_b128 v[236:239], v61 offset:3456
    s_waitcnt lgkmcnt(4)
    global_store_dwordx4 v52, v[224:227], s[30:31] offset:0 sc1
    global_store_dwordx4 v53, v[228:231], s[30:31] offset:0 sc1
    v_mfma_f32_16x16x32_bf16 v[160:163], v[96:99], v[24:27], 0
    v_mfma_f32_16x16x32_bf16 v[160:163], v[100:103], v[28:31], v[160:163]
    v_mfma_f32_16x16x32_bf16 v[164:167], v[104:107], v[24:27], 0
    v_mfma_f32_16x16x32_bf16 v[164:167], v[108:111], v[28:31], v[164:167]
    v_mfma_f32_16x16x32_bf16 v[168:171], v[112:115], v[24:27], 0
    v_mfma_f32_16x16x32_bf16 v[168:171], v[116:119], v[28:31], v[168:171]
    v_mfma_f32_16x16x32_bf16 v[172:175], v[120:123], v[24:27], 0
    v_mfma_f32_16x16x32_bf16 v[172:175], v[124:127], v[28:31], v[172:175]
    v_cvt_pk_bf16_f32 v208, v192, v193
    v_cvt_pk_bf16_f32 v209, v194, v195
    v_cvt_pk_bf16_f32 v210, v196, v197
    v_cvt_pk_bf16_f32 v211, v198, v199
    v_cvt_pk_bf16_f32 v212, v200, v201
    v_cvt_pk_bf16_f32 v213, v202, v203
    v_cvt_pk_bf16_f32 v214, v204, v205
    v_cvt_pk_bf16_f32 v215, v206, v207
    ds_write_b128 v60, v[208:211] offset:0
    ds_write_b128 v60, v[212:215] offset:64
    ds_read_b128 v[240:243], v61 offset:0
    ds_read_b128 v[244:247], v61 offset:1152
    s_waitcnt lgkmcnt(4)
    global_store_dwordx4 v54, v[232:235], s[30:31] offset:0 sc1
    global_store_dwordx4 v55, v[236:239], s[30:31] offset:0 sc1
    v_mfma_f32_16x16x32_bf16 v[176:179], v[128:131], v[16:19], 0
    v_mfma_f32_16x16x32_bf16 v[176:179], v[132:135], v[20:23], v[176:179]
    v_mfma_f32_16x16x32_bf16 v[180:183], v[136:139], v[16:19], 0
    v_mfma_f32_16x16x32_bf16 v[180:183], v[140:143], v[20:23], v[180:183]
    v_mfma_f32_16x16x32_bf16 v[184:187], v[144:147], v[16:19], 0
    v_mfma_f32_16x16x32_bf16 v[184:187], v[148:151], v[20:23], v[184:187]
    v_mfma_f32_16x16x32_bf16 v[188:191], v[152:155], v[16:19], 0
    v_mfma_f32_16x16x32_bf16 v[188:191], v[156:159], v[20:23], v[188:191]
    v_cvt_pk_bf16_f32 v216, v160, v161
    v_cvt_pk_bf16_f32 v217, v162, v163
    v_cvt_pk_bf16_f32 v218, v164, v165
    v_cvt_pk_bf16_f32 v219, v166, v167
    v_cvt_pk_bf16_f32 v220, v168, v169
    v_cvt_pk_bf16_f32 v221, v170, v171
    v_cvt_pk_bf16_f32 v222, v172, v173
    v_cvt_pk_bf16_f32 v223, v174, v175
    ds_write_b128 v60, v[216:219] offset:2304
    ds_write_b128 v60, v[220:223] offset:2368
    ds_read_b128 v[224:227], v61 offset:2304
    ds_read_b128 v[228:231], v61 offset:3456
    s_waitcnt lgkmcnt(4)
    global_store_dwordx4 v52, v[240:243], s[30:31] offset:128 sc1
    global_store_dwordx4 v53, v[244:247], s[30:31] offset:128 sc1
    v_mfma_f32_16x16x32_bf16 v[192:195], v[128:131], v[24:27], 0
    v_mfma_f32_16x16x32_bf16 v[192:195], v[132:135], v[28:31], v[192:195]
    v_mfma_f32_16x16x32_bf16 v[196:199], v[136:139], v[24:27], 0
    v_mfma_f32_16x16x32_bf16 v[196:199], v[140:143], v[28:31], v[196:199]
    v_mfma_f32_16x16x32_bf16 v[200:203], v[144:147], v[24:27], 0
    v_mfma_f32_16x16x32_bf16 v[200:203], v[148:151], v[28:31], v[200:203]
    v_mfma_f32_16x16x32_bf16 v[204:207], v[152:155], v[24:27], 0
    v_mfma_f32_16x16x32_bf16 v[204:207], v[156:159], v[28:31], v[204:207]
    v_cvt_pk_bf16_f32 v208, v176, v177
    v_cvt_pk_bf16_f32 v209, v178, v179
    v_cvt_pk_bf16_f32 v210, v180, v181
    v_cvt_pk_bf16_f32 v211, v182, v183
    v_cvt_pk_bf16_f32 v212, v184, v185
    v_cvt_pk_bf16_f32 v213, v186, v187
    v_cvt_pk_bf16_f32 v214, v188, v189
    v_cvt_pk_bf16_f32 v215, v190, v191
    ds_write_b128 v60, v[208:211] offset:0
    ds_write_b128 v60, v[212:215] offset:64
    ds_read_b128 v[232:235], v61 offset:0
    ds_read_b128 v[236:239], v61 offset:1152
    s_waitcnt lgkmcnt(4)
    global_store_dwordx4 v54, v[224:227], s[30:31] offset:128 sc1
    global_store_dwordx4 v55, v[228:231], s[30:31] offset:128 sc1
    v_cvt_pk_bf16_f32 v216, v192, v193
    v_cvt_pk_bf16_f32 v217, v194, v195
    v_cvt_pk_bf16_f32 v218, v196, v197
    v_cvt_pk_bf16_f32 v219, v198, v199
    v_cvt_pk_bf16_f32 v220, v200, v201
    v_cvt_pk_bf16_f32 v221, v202, v203
    v_cvt_pk_bf16_f32 v222, v204, v205
    v_cvt_pk_bf16_f32 v223, v206, v207
    ds_write_b128 v60, v[216:219] offset:2304
    ds_write_b128 v60, v[220:223] offset:2368
    ds_read_b128 v[240:243], v61 offset:2304
    ds_read_b128 v[244:247], v61 offset:3456
    s_waitcnt lgkmcnt(4)
    global_store_dwordx4 v52, v[232:235], s[30:31] offset:256 sc1
    global_store_dwordx4 v53, v[236:239], s[30:31] offset:256 sc1
    s_waitcnt lgkmcnt(0)
    global_store_dwordx4 v54, v[240:243], s[30:31] offset:256 sc1
    global_store_dwordx4 v55, v[244:247], s[30:31] offset:256 sc1
LB_pvd:
    v_mov_b32 v8, 1
    s_mov_b32 exec_lo, 0x1
    s_mov_b32 exec_hi, 0x0
    ds_add_u32 v58, v8
    s_mov_b64 exec, -1
    v_add_f32_dpp v49, v49, v49 row_ror:8 row_mask:0xf bank_mask:0xf
    s_nop 1
    v_add_f32_dpp v49, v49, v49 row_ror:4 row_mask:0xf bank_mask:0xf
    s_nop 1
    v_add_f32_dpp v49, v49, v49 row_ror:2 row_mask:0xf bank_mask:0xf
    s_nop 1
    v_add_f32_dpp v49, v49, v49 row_ror:1 row_mask:0xf bank_mask:0xf
    v_mov_b32 v48, v62
    ds_write_b64 v7, v[48:49]
    v_mov_b32 v8, 1
    s_mov_b64 exec, 1
    ds_add_u32 v58, v8 offset:16
    s_mov_b64 exec, -1
    s_sub_u32 s40, s54, 80
    s_cmp_lt_u32 s40, 24
    s_cbranch_scc0 LB_nrc0
    v_lshlrev_b32 v18, 4, v1
    v_add_u32 v18, 4096, v18
Lp_56:
    global_load_dword v16, v18, s[30:31] offset:0 sc1
    global_load_dword v17, v18, s[30:31] offset:1024 sc1
Lc_58:
    s_waitcnt vmcnt(0)
    v_cmp_ne_u32 vcc, s32, v16
    v_cmp_ne_u32 s[50:51], s32, v17
    s_or_b64 vcc, vcc, s[50:51]
    s_cbranch_vccz Ld_57
    s_add_u32 s33, s33, 1
    s_cmp_gt_u32 s33, 200000
    s_cbranch_scc1 Ld_57
    s_sleep 4
    s_branch Lp_56
Ld_57:
LB_nrc0:
Lw_59:
    ds_read_b32 v8, v58 offset:16
    ds_read_b64 v[36:37], v57
    s_waitcnt lgkmcnt(0)
    v_cmp_gt_u32 vcc, 8, v8
    s_cbranch_vccz Lwd_60
    s_add_u32 s33, s33, 1
    s_cmp_gt_u32 s33, 200000
    s_cbranch_scc1 Lwd_60
    s_sleep 1
    s_branch Lw_59
Lwd_60:
    v_mov_b32 v8, 1
    v_mov_b32 v29, s32
    v_mov_b32 v28, v36
    v_mov_b32 v30, v37
    v_mov_b32 v31, s32
    s_mov_b32 exec_lo, 0xffffffff
    s_mov_b32 exec_hi, 0x0
    s_waitcnt vmcnt(0)
    global_store_dwordx4 v56, v[28:31], s[30:31] sc1
    s_mov_b32 exec_lo, 0x1
    s_mov_b32 exec_hi, 0x0
    ds_add_u32 v58, v8 offset:12
    s_mov_b64 exec, -1
    v_and_b32 v8, 63, v44
    v_cmp_eq_u32 vcc, v40, v8
    s_nop 1
    v_cndmask_b32 v32, v32, v11, vcc
    v_cmp_eq_u32 vcc, v41, v8
    s_nop 1
    v_cndmask_b32 v33, v33, v11, vcc
    v_cmp_eq_u32 vcc, v42, v8
    s_nop 1
    v_cndmask_b32 v34, v34, v11, vcc
    v_cmp_eq_u32 vcc, v43, v8
    s_nop 1
    v_cndmask_b32 v35, v35, v11, vcc
    v_max3_f32 v50, v32, v33, v34
    v_max_f32 v50, v50, v35
    s_nop 1
    v_max_f32_dpp v50, v50, v50 row_ror:8 row_mask:0xf bank_mask:0xf
    s_nop 1
    v_max_f32_dpp v50, v50, v50 row_ror:4 row_mask:0xf bank_mask:0xf
    s_nop 1
    v_max_f32_dpp v50, v50, v50 row_ror:2 row_mask:0xf bank_mask:0xf
    s_nop 1
    v_max_f32_dpp v50, v50, v50 row_ror:1 row_mask:0xf bank_mask:0xf
    v_sub_f32 v24, v32, v50
    v_sub_f32 v25, v33, v50
    v_sub_f32 v26, v34, v50
    v_sub_f32 v27, v35, v50
    v_mul_f32 v24, s56, v24
    v_mul_f32 v25, s56, v25
    v_mul_f32 v26, s56, v26
    v_mul_f32 v27, s56, v27
    v_exp_f32 v24, v24
    v_exp_f32 v25, v25
    v_exp_f32 v26, v26
    v_exp_f32 v27, v27
    v_add_f32 v51, v24, v25
    v_add_f32 v48, v26, v27
    v_add_f32 v51, v51, v48
    v_cvt_pk_bf16_f32 v38, v24, v25
    v_cvt_pk_bf16_f32 v39, v26, v27
    ds_write_b64 v5, v[38:39] offset:4608
    v_add_f32_dpp v51, v51, v51 row_ror:8 row_mask:0xf bank_mask:0xf
    s_nop 1
    v_add_f32_dpp v51, v51, v51 row_ror:4 row_mask:0xf bank_mask:0xf
    s_nop 1
    v_add_f32_dpp v51, v51, v51 row_ror:2 row_mask:0xf bank_mask:0xf
    s_nop 1
    v_add_f32_dpp v51, v51, v51 row_ror:1 row_mask:0xf bank_mask:0xf
    ds_write_b64 v7, v[50:51] offset:8
    v_and_b32 v8, 63, v46
    v_cmp_eq_u32 vcc, v40, v8
    s_nop 1
    v_cndmask_b32 v32, v32, v11, vcc
    v_cmp_eq_u32 vcc, v41, v8
    s_nop 1
    v_cndmask_b32 v33, v33, v11, vcc
    v_cmp_eq_u32 vcc, v42, v8
    s_nop 1
    v_cndmask_b32 v34, v34, v11, vcc
    v_cmp_eq_u32 vcc, v43, v8
    s_nop 1
    v_cndmask_b32 v35, v35, v11, vcc
    v_max3_f32 v50, v32, v33, v34
    v_max_f32 v50, v50, v35
    s_nop 1
    v_max_f32_dpp v50, v50, v50 row_ror:8 row_mask:0xf bank_mask:0xf
    s_nop 1
    v_max_f32_dpp v50, v50, v50 row_ror:4 row_mask:0xf bank_mask:0xf
    s_nop 1
    v_max_f32_dpp v50, v50, v50 row_ror:2 row_mask:0xf bank_mask:0xf
    s_nop 1
    v_max_f32_dpp v50, v50, v50 row_ror:1 row_mask:0xf bank_mask:0xf
    v_sub_f32 v24, v32, v50
    v_sub_f32 v25, v33, v50
    v_sub_f32 v26, v34, v50
    v_sub_f32 v27, v35, v50
    v_mul_f32 v24, s56, v24
    v_mul_f32 v25, s56, v25
    v_mul_f32 v26, s56, v26
    v_mul_f32 v27, s56, v27
    v_exp_f32 v24, v24
    v_exp_f32 v25, v25
    v_exp_f32 v26, v26
    v_exp_f32 v27, v27
    v_add_f32 v51, v24, v25
    v_add_f32 v48, v26, v27
    v_add_f32 v51, v51, v48
    v_cvt_pk_bf16_f32 v38, v24, v25
    v_cvt_pk_bf16_f32 v39, v26, v27
    v_subrev_u32 v8, 20992, v5
    ds_write_b64 v8, v[38:39] offset:4608
    v_lshrrev_b32 v8, 1, v7
    v_add_f32_dpp v51, v51, v51 row_ror:8 row_mask:0xf bank_mask:0xf
    s_nop 1
    v_add_f32_dpp v51, v51, v51 row_ror:4 row_mask:0xf bank_mask:0xf
    s_nop 1
    v_add_f32_dpp v51, v51, v51 row_ror:2 row_mask:0xf bank_mask:0xf
    s_nop 1
    v_add_f32_dpp v51, v51, v51 row_ror:1 row_mask:0xf bank_mask:0xf
    v_add_u32 v8, 71936, v8
    ds_write_b64 v8, v[50:51]
    v_mov_b32 v8, 1
    s_mov_b64 exec, 1
    ds_add_u32 v58, v8 offset:20
    s_mov_b64 exec, -1
Lw_61:
    ds_read_b32 v8, v58 offset:20
    s_waitcnt lgkmcnt(0)
    v_cmp_gt_u32 vcc, 8, v8
    s_cbranch_vccz Lwd_62
    s_add_u32 s33, s33, 1
    s_cmp_gt_u32 s33, 200000
    s_cbranch_scc1 Lwd_62
    s_sleep 1
    s_branch Lw_61
Lwd_62:
    v_lshlrev_b32 v9, 2, v2
    v_add_u32 v9, 142912, v9
    s_lshl_b32 s40, s3, 9
    s_add_u32 s40, s40, 98304
    v_lshlrev_b32 v10, 13, v2
    v_lshl_add_u32 v10, v3, 4, v10
    v_add_u32 v10, s40, v10
    v_lshlrev_b32 v11, 4, v2
    v_add_u32 v11, 142336, v11
Lw_63:
    ds_read_b32 v8, v58 offset:4
    ds_read2_b32 v[40:41], v9 offset0:0 offset1:16
    s_waitcnt lgkmcnt(0)
    v_cmp_gt_u32 vcc, 1, v8
    s_cbranch_vccz Lwd_64
    s_add_u32 s33, s33, 1
    s_cmp_gt_u32 s33, 200000
    s_cbranch_scc1 Lwd_64
    s_sleep 1
    s_branch Lw_63
Lwd_64:
    v_cmp_gt_u32 s[42:43], 8, v40
    s_cmp_eq_u64 s[42:43], 0
    s_cbranch_scc1 LB_cn0
    v_and_b32 v8, 4, v40
    v_cmp_ne_u32 vcc, 0, v8
    v_subrev_u32 v8, 20992, v4
    s_nop 0
    v_cndmask_b32 v8, v4, v8, vcc
    ds_read_b128 v[16:19], v8 offset:4608
    ds_read_b128 v[20:23], v8 offset:4672
    v_lshlrev_b32 v43, 3, v2
    v_add_u32 v43, 143104, v43
    v_add_u32 v8, 8, v11
    v_cndmask_b32 v8, v8, v43, vcc
    ds_read_b64 v[44:45], v8
    v_and_b32 v42, 3, v40
    v_lshl_add_u32 v42, v42, 11, v10
    v_add_u32 v42, 0, v42
    s_waitcnt lgkmcnt(0)
    v_mfma_f32_16x16x32_bf16 v[160:163], v[64:67], v[16:19], 0
    v_mfma_f32_16x16x32_bf16 v[160:163], v[68:71], v[20:23], v[160:163]
    v_mfma_f32_16x16x32_bf16 v[164:167], v[72:75], v[16:19], 0
    v_mfma_f32_16x16x32_bf16 v[164:167], v[76:79], v[20:23], v[164:167]
    v_mfma_f32_16x16x32_bf16 v[168:171], v[80:83], v[16:19], 0
    v_mfma_f32_16x16x32_bf16 v[168:171], v[84:87], v[20:23], v[168:171]
    v_mfma_f32_16x16x32_bf16 v[172:175], v[88:91], v[16:19], 0
    v_mfma_f32_16x16x32_bf16 v[172:175], v[92:95], v[20:23], v[172:175]
    v_mfma_f32_16x16x32_bf16 v[176:179], v[96:99], v[16:19], 0
    v_mfma_f32_16x16x32_bf16 v[176:179], v[100:103], v[20:23], v[176:179]
    v_mfma_f32_16x16x32_bf16 v[180:183], v[104:107], v[16:19], 0
    v_mfma_f32_16x16x32_bf16 v[180:183], v[108:111], v[20:23], v[180:183]
    v_mfma_f32_16x16x32_bf16 v[184:187], v[112:115], v[16:19], 0
    v_mfma_f32_16x16x32_bf16 v[184:187], v[116:119], v[20:23], v[184:187]
    v_mfma_f32_16x16x32_bf16 v[188:191], v[120:123], v[16:19], 0
    v_mfma_f32_16x16x32_bf16 v[188:191], v[124:127], v[20:23], v[188:191]
    v_mfma_f32_16x16x32_bf16 v[192:195], v[128:131], v[16:19], 0
    v_mfma_f32_16x16x32_bf16 v[192:195], v[132:135], v[20:23], v[192:195]
    v_mfma_f32_16x16x32_bf16 v[196:199], v[136:139], v[16:19], 0
    v_mfma_f32_16x16x32_bf16 v[196:199], v[140:143], v[20:23], v[196:199]
    v_mfma_f32_16x16x32_bf16 v[200:203], v[144:147], v[16:19], 0
    v_mfma_f32_16x16x32_bf16 v[200:203], v[148:151], v[20:23], v[200:203]
    v_mfma_f32_16x16x32_bf16 v[204:207], v[152:155], v[16:19], 0
    v_mfma_f32_16x16x32_bf16 v[204:207], v[156:159], v[20:23], v[204:207]
    v_cvt_pk_bf16_f32 v208, v160, v161
    v_cvt_pk_bf16_f32 v209, v162, v163
    v_cvt_pk_bf16_f32 v210, v164, v165
    v_cvt_pk_bf16_f32 v211, v166, v167
    v_cvt_pk_bf16_f32 v212, v168, v169
    v_cvt_pk_bf16_f32 v213, v170, v171
    v_cvt_pk_bf16_f32 v214, v172, v173
    v_cvt_pk_bf16_f32 v215, v174, v175
    v_cvt_pk_bf16_f32 v216, v176, v177
    v_cvt_pk_bf16_f32 v217, v178, v179
    v_cvt_pk_bf16_f32 v218, v180, v181
    v_cvt_pk_bf16_f32 v219, v182, v183
    v_cvt_pk_bf16_f32 v220, v184, v185
    v_cvt_pk_bf16_f32 v221, v186, v187
    v_cvt_pk_bf16_f32 v222, v188, v189
    v_cvt_pk_bf16_f32 v223, v190, v191
    v_cvt_pk_bf16_f32 v224, v192, v193
    v_cvt_pk_bf16_f32 v225, v194, v195
    v_cvt_pk_bf16_f32 v226, v196, v197
    v_cvt_pk_bf16_f32 v227, v198, v199
    v_cvt_pk_bf16_f32 v228, v200, v201
    v_cvt_pk_bf16_f32 v229, v202, v203
    v_cvt_pk_bf16_f32 v230, v204, v205
    v_cvt_pk_bf16_f32 v231, v206, v207
    v_min_u32 v208, -2, v208
    v_min_u32 v209, -2, v209
    v_min_u32 v210, -2, v210
    v_min_u32 v211, -2, v211
    v_min_u32 v212, -2, v212
    v_min_u32 v213, -2, v213
    v_min_u32 v214, -2, v214
    v_min_u32 v215, -2, v215
    v_min_u32 v216, -2, v216
    v_min_u32 v217, -2, v217
    v_min_u32 v218, -2, v218
    v_min_u32 v219, -2, v219
    v_min_u32 v220, -2, v220
    v_min_u32 v221, -2, v221
    v_min_u32 v222, -2, v222
    v_min_u32 v223, -2, v223
    v_min_u32 v224, -2, v224
    v_min_u32 v225, -2, v225
    v_min_u32 v226, -2, v226
    v_min_u32 v227, -2, v227
    v_min_u32 v228, -2, v228
    v_min_u32 v229, -2, v229
    v_min_u32 v230, -2, v230
    v_min_u32 v231, -2, v231
    v_mov_b32 v46, v45
    v_mov_b32 v45, s32
    v_mov_b32 v47, s32
    s_mov_b64 exec, s[42:43]
    global_store_dwordx4 v42, v[208:211], s[30:31] offset:0 sc1
    global_store_dwordx4 v42, v[212:215], s[30:31] offset:64 sc1
    global_store_dwordx4 v42, v[216:219], s[30:31] offset:128 sc1
    global_store_dwordx4 v42, v[220:223], s[30:31] offset:192 sc1
    global_store_dwordx4 v42, v[224:227], s[30:31] offset:256 sc1
    global_store_dwordx4 v42, v[228:231], s[30:31] offset:320 sc1
    s_and_b64 exec, exec, 0xffff
    global_store_dwordx4 v42, v[44:47], s[30:31] offset:384 sc1
    s_mov_b64 exec, -1
LB_cn0:
    v_cmp_gt_u32 s[42:43], 8, v41
    s_cmp_eq_u64 s[42:43], 0
    s_cbranch_scc1 LB_cn1
    v_and_b32 v8, 4, v41
    v_cmp_ne_u32 vcc, 0, v8
    v_subrev_u32 v8, 20992, v4
    s_nop 0
    v_cndmask_b32 v8, v4, v8, vcc
    ds_read_b128 v[16:19], v8 offset:6912
    ds_read_b128 v[20:23], v8 offset:6976
    v_lshlrev_b32 v43, 3, v2
    v_add_u32 v43, 143232, v43
    v_add_u32 v8, 264, v11
    v_cndmask_b32 v8, v8, v43, vcc
    ds_read_b64 v[44:45], v8
    v_and_b32 v42, 3, v41
    v_lshl_add_u32 v42, v42, 11, v10
    v_add_u32 v42, 131072, v42
    s_waitcnt lgkmcnt(0)
    v_mfma_f32_16x16x32_bf16 v[160:163], v[64:67], v[16:19], 0
    v_mfma_f32_16x16x32_bf16 v[160:163], v[68:71], v[20:23], v[160:163]
    v_mfma_f32_16x16x32_bf16 v[164:167], v[72:75], v[16:19], 0
    v_mfma_f32_16x16x32_bf16 v[164:167], v[76:79], v[20:23], v[164:167]
    v_mfma_f32_16x16x32_bf16 v[168:171], v[80:83], v[16:19], 0
    v_mfma_f32_16x16x32_bf16 v[168:171], v[84:87], v[20:23], v[168:171]
    v_mfma_f32_16x16x32_bf16 v[172:175], v[88:91], v[16:19], 0
    v_mfma_f32_16x16x32_bf16 v[172:175], v[92:95], v[20:23], v[172:175]
    v_mfma_f32_16x16x32_bf16 v[176:179], v[96:99], v[16:19], 0
    v_mfma_f32_16x16x32_bf16 v[176:179], v[100:103], v[20:23], v[176:179]
    v_mfma_f32_16x16x32_bf16 v[180:183], v[104:107], v[16:19], 0
    v_mfma_f32_16x16x32_bf16 v[180:183], v[108:111], v[20:23], v[180:183]
    v_mfma_f32_16x16x32_bf16 v[184:187], v[112:115], v[16:19], 0
    v_mfma_f32_16x16x32_bf16 v[184:187], v[116:119], v[20:23], v[184:187]
    v_mfma_f32_16x16x32_bf16 v[188:191], v[120:123], v[16:19], 0
    v_mfma_f32_16x16x32_bf16 v[188:191], v[124:127], v[20:23], v[188:191]
    v_mfma_f32_16x16x32_bf16 v[192:195], v[128:131], v[16:19], 0
    v_mfma_f32_16x16x32_bf16 v[192:195], v[132:135], v[20:23], v[192:195]
    v_mfma_f32_16x16x32_bf16 v[196:199], v[136:139], v[16:19], 0
    v_mfma_f32_16x16x32_bf16 v[196:199], v[140:143], v[20:23], v[196:199]
    v_mfma_f32_16x16x32_bf16 v[200:203], v[144:147], v[16:19], 0
    v_mfma_f32_16x16x32_bf16 v[200:203], v[148:151], v[20:23], v[200:203]
    v_mfma_f32_16x16x32_bf16 v[204:207], v[152:155], v[16:19], 0
    v_mfma_f32_16x16x32_bf16 v[204:207], v[156:159], v[20:23], v[204:207]
    v_cvt_pk_bf16_f32 v208, v160, v161
    v_cvt_pk_bf16_f32 v209, v162, v163
    v_cvt_pk_bf16_f32 v210, v164, v165
    v_cvt_pk_bf16_f32 v211, v166, v167
    v_cvt_pk_bf16_f32 v212, v168, v169
    v_cvt_pk_bf16_f32 v213, v170, v171
    v_cvt_pk_bf16_f32 v214, v172, v173
    v_cvt_pk_bf16_f32 v215, v174, v175
    v_cvt_pk_bf16_f32 v216, v176, v177
    v_cvt_pk_bf16_f32 v217, v178, v179
    v_cvt_pk_bf16_f32 v218, v180, v181
    v_cvt_pk_bf16_f32 v219, v182, v183
    v_cvt_pk_bf16_f32 v220, v184, v185
    v_cvt_pk_bf16_f32 v221, v186, v187
    v_cvt_pk_bf16_f32 v222, v188, v189
    v_cvt_pk_bf16_f32 v223, v190, v191
    v_cvt_pk_bf16_f32 v224, v192, v193
    v_cvt_pk_bf16_f32 v225, v194, v195
    v_cvt_pk_bf16_f32 v226, v196, v197
    v_cvt_pk_bf16_f32 v227, v198, v199
    v_cvt_pk_bf16_f32 v228, v200, v201
    v_cvt_pk_bf16_f32 v229, v202, v203
    v_cvt_pk_bf16_f32 v230, v204, v205
    v_cvt_pk_bf16_f32 v231, v206, v207
    v_min_u32 v208, -2, v208
    v_min_u32 v209, -2, v209
    v_min_u32 v210, -2, v210
    v_min_u32 v211, -2, v211
    v_min_u32 v212, -2, v212
    v_min_u32 v213, -2, v213
    v_min_u32 v214, -2, v214
    v_min_u32 v215, -2, v215
    v_min_u32 v216, -2, v216
    v_min_u32 v217, -2, v217
    v_min_u32 v218, -2, v218
    v_min_u32 v219, -2, v219
    v_min_u32 v220, -2, v220
    v_min_u32 v221, -2, v221
    v_min_u32 v222, -2, v222
    v_min_u32 v223, -2, v223
    v_min_u32 v224, -2, v224
    v_min_u32 v225, -2, v225
    v_min_u32 v226, -2, v226
    v_min_u32 v227, -2, v227
    v_min_u32 v228, -2, v228
    v_min_u32 v229, -2, v229
    v_min_u32 v230, -2, v230
    v_min_u32 v231, -2, v231
    v_mov_b32 v46, v45
    v_mov_b32 v45, s32
    v_mov_b32 v47, s32
    s_mov_b64 exec, s[42:43]
    global_store_dwordx4 v42, v[208:211], s[30:31] offset:0 sc1
    global_store_dwordx4 v42, v[212:215], s[30:31] offset:64 sc1
    global_store_dwordx4 v42, v[216:219], s[30:31] offset:128 sc1
    global_store_dwordx4 v42, v[220:223], s[30:31] offset:192 sc1
    global_store_dwordx4 v42, v[224:227], s[30:31] offset:256 sc1
    global_store_dwordx4 v42, v[228:231], s[30:31] offset:320 sc1
    s_and_b64 exec, exec, 0xffff
    global_store_dwordx4 v42, v[44:47], s[30:31] offset:384 sc1
    s_mov_b64 exec, -1
LB_cn1:
    v_mov_b32 v8, 1
    s_mov_b32 exec_lo, 0x1
    s_mov_b32 exec_hi, 0x0
    ds_add_u32 v58, v8
    s_mov_b64 exec, -1
    s_branch LB_lw2
LB_lw:
    s_setprio 0
    v_add_f32_dpp v49, v49, v49 row_ror:8 row_mask:0xf bank_mask:0xf
    s_nop 1
    v_add_f32_dpp v49, v49, v49 row_ror:4 row_mask:0xf bank_mask:0xf
    s_nop 1
    v_add_f32_dpp v49, v49, v49 row_ror:2 row_mask:0xf bank_mask:0xf
    s_nop 1
    v_add_f32_dpp v49, v49, v49 row_ror:1 row_mask:0xf bank_mask:0xf
    v_mov_b32 v48, v62
    ds_write_b64 v7, v[48:49]
    v_mov_b32 v8, 1
    s_mov_b64 exec, 1
    ds_add_u32 v58, v8 offset:16
    s_mov_b64 exec, -1
    v_and_b32 v8, 63, v44
    v_cmp_eq_u32 vcc, v40, v8
    s_nop 1
    v_cndmask_b32 v32, v32, v11, vcc
    v_cmp_eq_u32 vcc, v41, v8
    s_nop 1
    v_cndmask_b32 v33, v33, v11, vcc
    v_cmp_eq_u32 vcc, v42, v8
    s_nop 1
    v_cndmask_b32 v34, v34, v11, vcc
    v_cmp_eq_u32 vcc, v43, v8
    s_nop 1
    v_cndmask_b32 v35, v35, v11, vcc
    v_max3_f32 v50, v32, v33, v34
    v_max_f32 v50, v50, v35
    s_nop 1
    v_max_f32_dpp v50, v50, v50 row_ror:8 row_mask:0xf bank_mask:0xf
    s_nop 1
    v_max_f32_dpp v50, v50, v50 row_ror:4 row_mask:0xf bank_mask:0xf
    s_nop 1
    v_max_f32_dpp v50, v50, v50 row_ror:2 row_mask:0xf bank_mask:0xf
    s_nop 1
    v_max_f32_dpp v50, v50, v50 row_ror:1 row_mask:0xf bank_mask:0xf
    v_sub_f32 v24, v32, v50
    v_sub_f32 v25, v33, v50
    v_sub_f32 v26, v34, v50
    v_sub_f32 v27, v35, v50
    v_mul_f32 v24, s56, v24
    v_mul_f32 v25, s56, v25
    v_mul_f32 v26, s56, v26
    v_mul_f32 v27, s56, v27
    v_exp_f32 v24, v24
    v_exp_f32 v25, v25
    v_exp_f32 v26, v26
    v_exp_f32 v27, v27
    v_add_f32 v51, v24, v25
    v_add_f32 v48, v26, v27
    v_add_f32 v51, v51, v48
    v_cvt_pk_bf16_f32 v38, v24, v25
    v_cvt_pk_bf16_f32 v39, v26, v27
    ds_write_b64 v5, v[38:39] offset:4608
    v_add_f32_dpp v51, v51, v51 row_ror:8 row_mask:0xf bank_mask:0xf
    s_nop 1
    v_add_f32_dpp v51, v51, v51 row_ror:4 row_mask:0xf bank_mask:0xf
    s_nop 1
    v_add_f32_dpp v51, v51, v51 row_ror:2 row_mask:0xf bank_mask:0xf
    s_nop 1
    v_add_f32_dpp v51, v51, v51 row_ror:1 row_mask:0xf bank_mask:0xf
    ds_write_b64 v7, v[50:51] offset:8
    v_and_b32 v8, 63, v46
    v_cmp_eq_u32 vcc, v40, v8
    s_nop 1
    v_cndmask_b32 v32, v32, v11, vcc
    v_cmp_eq_u32 vcc, v41, v8
    s_nop 1
    v_cndmask_b32 v33, v33, v11, vcc
    v_cmp_eq_u32 vcc, v42, v8
    s_nop 1
    v_cndmask_b32 v34, v34, v11, vcc
    v_cmp_eq_u32 vcc, v43, v8
    s_nop 1
    v_cndmask_b32 v35, v35, v11, vcc
    v_max3_f32 v50, v32, v33, v34
    v_max_f32 v50, v50, v35
    s_nop 1
    v_max_f32_dpp v50, v50, v50 row_ror:8 row_mask:0xf bank_mask:0xf
    s_nop 1
    v_max_f32_dpp v50, v50, v50 row_ror:4 row_mask:0xf bank_mask:0xf
    s_nop 1
    v_max_f32_dpp v50, v50, v50 row_ror:2 row_mask:0xf bank_mask:0xf
    s_nop 1
    v_max_f32_dpp v50, v50, v50 row_ror:1 row_mask:0xf bank_mask:0xf
    v_sub_f32 v24, v32, v50
    v_sub_f32 v25, v33, v50
    v_sub_f32 v26, v34, v50
    v_sub_f32 v27, v35, v50
    v_mul_f32 v24, s56, v24
    v_mul_f32 v25, s56, v25
    v_mul_f32 v26, s56, v26
    v_mul_f32 v27, s56, v27
    v_exp_f32 v24, v24
    v_exp_f32 v25, v25
    v_exp_f32 v26, v26
    v_exp_f32 v27, v27
    v_add_f32 v51, v24, v25
    v_add_f32 v48, v26, v27
    v_add_f32 v51, v51, v48
    v_cvt_pk_bf16_f32 v38, v24, v25
    v_cvt_pk_bf16_f32 v39, v26, v27
    v_subrev_u32 v8, 20992, v5
    ds_write_b64 v8, v[38:39] offset:4608
    v_lshrrev_b32 v8, 1, v7
    v_add_f32_dpp v51, v51, v51 row_ror:8 row_mask:0xf bank_mask:0xf
    s_nop 1
    v_add_f32_dpp v51, v51, v51 row_ror:4 row_mask:0xf bank_mask:0xf
    s_nop 1
    v_add_f32_dpp v51, v51, v51 row_ror:2 row_mask:0xf bank_mask:0xf
    s_nop 1
    v_add_f32_dpp v51, v51, v51 row_ror:1 row_mask:0xf bank_mask:0xf
    v_add_u32 v8, 71936, v8
    ds_write_b64 v8, v[50:51]
    v_mov_b32 v8, 1
    s_mov_b64 exec, 1
    ds_add_u32 v58, v8 offset:20
    s_mov_b64 exec, -1
    s_sub_u32 s40, s54, 80
    s_cmp_lt_u32 s40, 24
    s_cbranch_scc0 LB_nrc1
    v_lshlrev_b32 v18, 4, v1
    v_add_u32 v18, 4096, v18
Lp_65:
    global_load_dword v16, v18, s[30:31] offset:0 sc1
    global_load_dword v17, v18, s[30:31] offset:1024 sc1
Lc_67:
    s_waitcnt vmcnt(0)
    v_cmp_ne_u32 vcc, s32, v16
    v_cmp_ne_u32 s[50:51], s32, v17
    s_or_b64 vcc, vcc, s[50:51]
    s_cbranch_vccz Ld_66
    s_add_u32 s33, s33, 1
    s_cmp_gt_u32 s33, 200000
    s_cbranch_scc1 Ld_66
    s_sleep 4
    s_branch Lp_65
Ld_66:
LB_nrc1:
    s_cmp_eq_u32 s3, 4
    s_cbranch_scc0 LB_lw3
    v_and_b32 v9, 31, v1
    v_lshlrev_b32 v10, 2, v9
    v_add_u32 v10, 142912, v10
    s_lshl_b32 s40, s39, 4
    s_add_u32 s40, s40, s38
    s_lshl_b32 s40, s40, 8
    s_add_u32 s40, s40, 491520
    v_lshl_add_u32 v9, v9, 3, s40
Lw_68:
    ds_read_b32 v8, v58 offset:0
    s_waitcnt lgkmcnt(0)
    v_cmp_gt_u32 vcc, 4, v8
    s_cbranch_vccz Lwd_69
    s_add_u32 s33, s33, 1
    s_cmp_gt_u32 s33, 200000
    s_cbranch_scc1 Lwd_69
    s_sleep 2
    s_branch Lw_68
Lwd_69:
Lp_70:
    global_load_dwordx2 v[16:17], v9, s[30:31] sc1
Lc_72:
    s_waitcnt vmcnt(0)
    v_cmp_ne_u32 vcc, s32, v17
    s_cbranch_vccz Ld_71
    s_add_u32 s33, s33, 1
    s_cmp_gt_u32 s33, 200000
    s_cbranch_scc1 Ld_71
    s_sleep 1
    s_branch Lp_70
Ld_71:
    ds_write_b32 v10, v16
    v_mov_b32 v8, 1
    ds_write_b32 v58, v8 offset:4
LB_lw2:
Lw_73:
    ds_read_b32 v8, v58 offset:0
    s_waitcnt lgkmcnt(0)
    v_cmp_gt_u32 vcc, 8, v8
    s_cbranch_vccz Lwd_74
    s_add_u32 s33, s33, 1
    s_cmp_gt_u32 s33, 200000
    s_cbranch_scc1 Lwd_74
    s_sleep 1
    s_branch Lw_73
Lwd_74:
    s_branch LB_late
LB_lw3:
Lw_75:
    ds_read_b32 v8, v58 offset:12
    s_waitcnt lgkmcnt(0)
    v_cmp_gt_u32 vcc, 4, v8
    s_cbranch_vccz Lwd_76
    s_add_u32 s33, s33, 1
    s_cmp_gt_u32 s33, 200000
    s_cbranch_scc1 Lwd_76
    s_sleep 1
    s_branch Lw_75
Lwd_76:
LB_late:
    s_cmp_lt_u32 s54, 80
    s_cbranch_scc0 LB_hi
    s_cmp_ge_u32 s3, 4
    s_cbranch_scc0 LB_wob
    s_mul_i32 s40, s39, 768
    s_mul_i32 s41, s45, 192
    s_add_u32 s40, s40, s41
    s_lshl_b32 s41, s38, 7
    v_lshrrev_b32 v4, 3, v2
    v_lshlrev_b32 v4, 5, v4
    v_lshl_add_u32 v4, v3, 3, v4
    v_add_u32 v4, s40, v4
    v_mul_u32_u24 v4, 1280, v4
    v_and_b32 v5, 7, v2
    v_lshl_add_u32 v4, v5, 4, v4
    v_add_u32 v4, s41, v4
    v_add_u32 v5, 81920, v4
    v_add_u32 v6, 163840, v4
    global_load_dwordx4 v[64:67], v4, s[14:15] offset:0 nt
    global_load_dwordx4 v[68:71], v4, s[14:15] offset:1280 nt
    global_load_dwordx4 v[72:75], v4, s[14:15] offset:2560 nt
    global_load_dwordx4 v[76:79], v4, s[14:15] offset:3840 nt
    v_add_u32 v4, 5120, v4
    global_load_dwordx4 v[80:83], v4, s[14:15] offset:0 nt
    global_load_dwordx4 v[84:87], v4, s[14:15] offset:1280 nt
    global_load_dwordx4 v[88:91], v4, s[14:15] offset:2560 nt
    global_load_dwordx4 v[92:95], v4, s[14:15] offset:3840 nt
Lw_77:
    ds_read_b32 v8, v58 offset:0
    s_waitcnt lgkmcnt(0)
    v_cmp_gt_u32 vcc, 8, v8
    s_cbranch_vccz Lwd_78
    s_add_u32 s33, s33, 1
    s_cmp_gt_u32 s33, 200000
    s_cbranch_scc1 Lwd_78
    s_sleep 1
    s_branch Lw_77
Lwd_78:
    global_load_dwordx4 v[96:99], v5, s[14:15] offset:0 nt
    global_load_dwordx4 v[100:103], v5, s[14:15] offset:1280 nt
    global_load_dwordx4 v[104:107], v5, s[14:15] offset:2560 nt
    global_load_dwordx4 v[108:111], v5, s[14:15] offset:3840 nt
    v_add_u32 v5, 5120, v5
    global_load_dwordx4 v[112:115], v5, s[14:15] offset:0 nt
    global_load_dwordx4 v[116:119], v5, s[14:15] offset:1280 nt
    global_load_dwordx4 v[120:123], v5, s[14:15] offset:2560 nt
    global_load_dwordx4 v[124:127], v5, s[14:15] offset:3840 nt
    global_load_dwordx4 v[128:131], v6, s[14:15] offset:0 nt
    global_load_dwordx4 v[132:135], v6, s[14:15] offset:1280 nt
    global_load_dwordx4 v[136:139], v6, s[14:15] offset:2560 nt
    global_load_dwordx4 v[140:143], v6, s[14:15] offset:3840 nt
    v_add_u32 v6, 5120, v6
    global_load_dwordx4 v[144:147], v6, s[14:15] offset:0 nt
    global_load_dwordx4 v[148:151], v6, s[14:15] offset:1280 nt
    global_load_dwordx4 v[152:155], v6, s[14:15] offset:2560 nt
    global_load_dwordx4 v[156:159], v6, s[14:15] offset:3840 nt
    s_mul_i32 s40, s39, 12
    s_mul_i32 s41, s45, 3
    s_add_u32 s40, s40, s41
    s_lshl_b32 s40, s40, 10
    s_add_u32 s40, s40, 950272
    v_lshl_add_u32 v4, v1, 4, s40
    s_mul_i32 s40, s45, 384
    s_add_u32 s40, s40, 147456
    v_lshl_add_u32 v5, v2, 2, v3
    v_lshl_add_u32 v5, v5, 1, s40
    v_and_b32 v6, 1, v2
    v_lshlrev_b32 v6, 6, v6
    v_lshl_add_u32 v6, v3, 4, v6
    v_add_u32 v6, s40, v6
    s_lshl_b32 s40, s3, 8
    s_add_u32 s40, s40, 144384
    v_and_b32 v14, 7, v2
    v_lshlrev_b32 v14, 5, v14
    v_lshrrev_b32 v15, 3, v2
    v_lshl_add_u32 v14, v15, 4, v14
    v_add_u32 v14, s40, v14
    s_waitcnt vmcnt(16)
    v_perm_b32 v160, v68, v64, s34
    v_perm_b32 v161, v76, v72, s34
    v_perm_b32 v162, v84, v80, s34
    v_perm_b32 v163, v92, v88, s34
    v_perm_b32 v164, v68, v64, s35
    v_perm_b32 v165, v76, v72, s35
    v_perm_b32 v166, v84, v80, s35
    v_perm_b32 v167, v92, v88, s35
    v_perm_b32 v168, v69, v65, s34
    v_perm_b32 v169, v77, v73, s34
    v_perm_b32 v170, v85, v81, s34
    v_perm_b32 v171, v93, v89, s34
    v_perm_b32 v172, v69, v65, s35
    v_perm_b32 v173, v77, v73, s35
    v_perm_b32 v174, v85, v81, s35
    v_perm_b32 v175, v93, v89, s35
    v_perm_b32 v176, v70, v66, s34
    v_perm_b32 v177, v78, v74, s34
    v_perm_b32 v178, v86, v82, s34
    v_perm_b32 v179, v94, v90, s34
    v_perm_b32 v180, v70, v66, s35
    v_perm_b32 v181, v78, v74, s35
    v_perm_b32 v182, v86, v82, s35
    v_perm_b32 v183, v94, v90, s35
    v_perm_b32 v184, v71, v67, s34
    v_perm_b32 v185, v79, v75, s34
    v_perm_b32 v186, v87, v83, s34
    v_perm_b32 v187, v95, v91, s34
    v_perm_b32 v188, v71, v67, s35
    v_perm_b32 v189, v79, v75, s35
    v_perm_b32 v190, v87, v83, s35
    v_perm_b32 v191, v95, v91, s35
    s_waitcnt vmcnt(8)
    v_perm_b32 v192, v100, v96, s34
    v_perm_b32 v193, v108, v104, s34
    v_perm_b32 v194, v116, v112, s34
    v_perm_b32 v195, v124, v120, s34
    v_perm_b32 v196, v100, v96, s35
    v_perm_b32 v197, v108, v104, s35
    v_perm_b32 v198, v116, v112, s35
    v_perm_b32 v199, v124, v120, s35
    v_perm_b32 v200, v101, v97, s34
    v_perm_b32 v201, v109, v105, s34
    v_perm_b32 v202, v117, v113, s34
    v_perm_b32 v203, v125, v121, s34
    v_perm_b32 v204, v101, v97, s35
    v_perm_b32 v205, v109, v105, s35
    v_perm_b32 v206, v117, v113, s35
    v_perm_b32 v207, v125, v121, s35
    v_perm_b32 v208, v102, v98, s34
    v_perm_b32 v209, v110, v106, s34
    v_perm_b32 v210, v118, v114, s34
    v_perm_b32 v211, v126, v122, s34
    v_perm_b32 v212, v102, v98, s35
    v_perm_b32 v213, v110, v106, s35
    v_perm_b32 v214, v118, v114, s35
    v_perm_b32 v215, v126, v122, s35
    v_perm_b32 v216, v103, v99, s34
    v_perm_b32 v217, v111, v107, s34
    v_perm_b32 v218, v119, v115, s34
    v_perm_b32 v219, v127, v123, s34
    v_perm_b32 v220, v103, v99, s35
    v_perm_b32 v221, v111, v107, s35
    v_perm_b32 v222, v119, v115, s35
    v_perm_b32 v223, v127, v123, s35
    s_waitcnt vmcnt(0)
    v_perm_b32 v224, v132, v128, s34
    v_perm_b32 v225, v140, v136, s34
    v_perm_b32 v226, v148, v144, s34
    v_perm_b32 v227, v156, v152, s34
    v_perm_b32 v228, v132, v128, s35
    v_perm_b32 v229, v140, v136, s35
    v_perm_b32 v230, v148, v144, s35
    v_perm_b32 v231, v156, v152, s35
    v_perm_b32 v232, v133, v129, s34
    v_perm_b32 v233, v141, v137, s34
    v_perm_b32 v234, v149, v145, s34
    v_perm_b32 v235, v157, v153, s34
    v_perm_b32 v236, v133, v129, s35
    v_perm_b32 v237, v141, v137, s35
    v_perm_b32 v238, v149, v145, s35
    v_perm_b32 v239, v157, v153, s35
    v_perm_b32 v240, v134, v130, s34
    v_perm_b32 v241, v142, v138, s34
    v_perm_b32 v242, v150, v146, s34
    v_perm_b32 v243, v158, v154, s34
    v_perm_b32 v244, v134, v130, s35
    v_perm_b32 v245, v142, v138, s35
    v_perm_b32 v246, v150, v146, s35
    v_perm_b32 v247, v158, v154, s35
    v_perm_b32 v248, v135, v131, s34
    v_perm_b32 v249, v143, v139, s34
    v_perm_b32 v250, v151, v147, s34
    v_perm_b32 v251, v159, v155, s34
    v_perm_b32 v252, v135, v131, s35
    v_perm_b32 v253, v143, v139, s35
    v_perm_b32 v254, v151, v147, s35
    v_perm_b32 v255, v159, v155, s35
Lp_79:
    global_load_dwordx4 v[16:19], v4, s[30:31] offset:0 sc1
    global_load_dwordx4 v[20:23], v4, s[30:31] offset:1024 sc1
    global_load_dwordx4 v[24:27], v4, s[30:31] offset:2048 sc1
Lc_81:
    s_waitcnt vmcnt(0)
    v_max3_u32 v8, v16, v17, v18
    v_max3_u32 v8, v8, v19, v20
    v_max3_u32 v8, v8, v21, v22
    v_max3_u32 v8, v8, v23, v24
    v_max3_u32 v8, v8, v25, v26
    v_max_u32 v8, v8, v27
    v_cmp_eq_u32 vcc, -1, v8
    s_cbranch_vccz Ld_80
    s_add_u32 s33, s33, 1
    s_cmp_gt_u32 s33, 200000
    s_cbranch_scc1 Ld_80
    s_sleep 1
    s_branch Lp_79
Ld_80:
    s_setprio 3
    v_permlane16_swap_b32 v16, v17
    v_permlane16_swap_b32 v18, v19
    v_add_f32 v16, v16, v17
    v_add_f32 v18, v18, v19
    s_nop 1
    v_permlane32_swap_b32 v16, v18
    v_add_f32 v16, v16, v18
    v_permlane16_swap_b32 v20, v21
    v_permlane16_swap_b32 v22, v23
    v_add_f32 v20, v20, v21
    v_add_f32 v22, v22, v23
    s_nop 1
    v_permlane32_swap_b32 v20, v22
    v_add_f32 v20, v20, v22
    v_permlane16_swap_b32 v24, v25
    v_permlane16_swap_b32 v26, v27
    v_add_f32 v24, v24, v25
    v_add_f32 v26, v26, v27
    s_nop 1
    v_permlane32_swap_b32 v24, v26
    v_add_f32 v24, v24, v26
    v_cvt_pk_bf16_f32 v16, v16, v16
    ds_write_b16 v5, v16 offset:0
    v_cvt_pk_bf16_f32 v20, v20, v20
    ds_write_b16 v5, v20 offset:128
    v_cvt_pk_bf16_f32 v24, v24, v24
    ds_write_b16 v5, v24 offset:256
    s_waitcnt lgkmcnt(0)
    ds_read_b128 v[16:19], v6 offset:0
    ds_read_b128 v[20:23], v6 offset:128
    ds_read_b128 v[24:27], v6 offset:256
    s_waitcnt lgkmcnt(2)
    v_mfma_f32_16x16x32_bf16 v[64:67], v[16:19], v[160:163], 0
    v_mfma_f32_16x16x32_bf16 v[68:71], v[16:19], v[164:167], 0
    v_mfma_f32_16x16x32_bf16 v[72:75], v[16:19], v[168:171], 0
    v_mfma_f32_16x16x32_bf16 v[76:79], v[16:19], v[172:175], 0
    v_mfma_f32_16x16x32_bf16 v[80:83], v[16:19], v[176:179], 0
    v_mfma_f32_16x16x32_bf16 v[84:87], v[16:19], v[180:183], 0
    v_mfma_f32_16x16x32_bf16 v[88:91], v[16:19], v[184:187], 0
    v_mfma_f32_16x16x32_bf16 v[92:95], v[16:19], v[188:191], 0
    s_waitcnt lgkmcnt(1)
    v_mfma_f32_16x16x32_bf16 v[64:67], v[20:23], v[192:195], v[64:67]
    v_mfma_f32_16x16x32_bf16 v[68:71], v[20:23], v[196:199], v[68:71]
    v_mfma_f32_16x16x32_bf16 v[72:75], v[20:23], v[200:203], v[72:75]
    v_mfma_f32_16x16x32_bf16 v[76:79], v[20:23], v[204:207], v[76:79]
    v_mfma_f32_16x16x32_bf16 v[80:83], v[20:23], v[208:211], v[80:83]
    v_mfma_f32_16x16x32_bf16 v[84:87], v[20:23], v[212:215], v[84:87]
    v_mfma_f32_16x16x32_bf16 v[88:91], v[20:23], v[216:219], v[88:91]
    v_mfma_f32_16x16x32_bf16 v[92:95], v[20:23], v[220:223], v[92:95]
    s_waitcnt lgkmcnt(0)
    v_mfma_f32_16x16x32_bf16 v[64:67], v[24:27], v[224:227], v[64:67]
    v_mfma_f32_16x16x32_bf16 v[68:71], v[24:27], v[228:231], v[68:71]
    v_mfma_f32_16x16x32_bf16 v[72:75], v[24:27], v[232:235], v[72:75]
    v_mfma_f32_16x16x32_bf16 v[76:79], v[24:27], v[236:239], v[76:79]
    v_mfma_f32_16x16x32_bf16 v[80:83], v[24:27], v[240:243], v[80:83]
    v_mfma_f32_16x16x32_bf16 v[84:87], v[24:27], v[244:247], v[84:87]
    v_mfma_f32_16x16x32_bf16 v[88:91], v[24:27], v[248:251], v[88:91]
    v_mfma_f32_16x16x32_bf16 v[92:95], v[24:27], v[252:255], v[92:95]
    s_nop 0
    v_add_f32_dpp v8, v65, v64 row_ror:8 row_mask:0xf bank_mask:0x3
    v_add_f32_dpp v9, v69, v68 row_ror:8 row_mask:0xf bank_mask:0x3
    v_add_f32_dpp v10, v73, v72 row_ror:8 row_mask:0xf bank_mask:0x3
    v_add_f32_dpp v11, v77, v76 row_ror:8 row_mask:0xf bank_mask:0x3
    v_add_f32_dpp v8, v80, v81 row_ror:8 row_mask:0xf bank_mask:0xc
    v_add_f32_dpp v9, v84, v85 row_ror:8 row_mask:0xf bank_mask:0xc
    v_add_f32_dpp v10, v88, v89 row_ror:8 row_mask:0xf bank_mask:0xc
    v_add_f32_dpp v11, v92, v93 row_ror:8 row_mask:0xf bank_mask:0xc
    s_mov_b32 exec_lo, 0xffff
    s_mov_b32 exec_hi, 0x0
    ds_write_b128 v14, v[8:11]
    s_mov_b64 exec, -1
LB_wob:
    v_lshlrev_b32 v4, 4, v2
    v_add_u32 v4, 145408, v4
    s_mul_i32 s40, s39, 2560
    s_lshl_b32 s41, s38, 8
    s_add_u32 s40, s40, s41
    s_add_u32 s40, s40, 1048576
    v_lshl_add_u32 v5, v2, 4, s40
    s_waitcnt lgkmcnt(0)
    s_barrier
    s_cmp_eq_u32 s3, 4
    s_cbranch_scc0 Lfin
    ds_read_b128 v[16:19], v4 offset:0
    ds_read_b128 v[20:23], v4 offset:256
    ds_read_b128 v[24:27], v4 offset:512
    ds_read_b128 v[28:31], v4 offset:768
    s_waitcnt lgkmcnt(0)
    v_add_f32 v16, v16, v20
    v_add_f32 v17, v17, v21
    v_add_f32 v18, v18, v22
    v_add_f32 v19, v19, v23
    v_add_f32 v24, v24, v28
    v_add_f32 v25, v25, v29
    v_add_f32 v26, v26, v30
    v_add_f32 v27, v27, v31
    v_add_f32 v16, v16, v24
    v_add_f32 v17, v17, v25
    v_add_f32 v18, v18, v26
    v_add_f32 v19, v19, v27
    s_mov_b32 exec_lo, 0xffff
    s_mov_b32 exec_hi, 0x0
    global_store_dwordx4 v5, v[16:19], s[30:31] sc1
    s_mov_b64 exec, -1
    s_branch Lfin
LB_hi:
    s_cmp_lt_u32 s54, 104
    s_cbranch_scc0 LB_mr
    s_sub_u32 s46, s54, 80
    s_lshl_b32 s40, s46, 6
    s_lshl_b32 s41, s3, 7
    v_lshrrev_b32 v10, 3, v2
    v_lshlrev_b32 v10, 5, v10
    v_lshl_add_u32 v10, v3, 3, v10
    v_add_u32 v10, s40, v10
    v_mul_u32_u24 v10, 1280, v10
    v_and_b32 v11, 7, v2
    v_lshl_add_u32 v10, v11, 4, v10
    v_add_u32 v10, s41, v10
    s_add_u32 s45, s3, 3
    s_and_b32 s45, s45, 7
    s_lshl_b32 s40, s45, 6
    v_add_u32 v62, s40, v1
    s_cmp_lt_u32 s45, 5
    s_cbranch_scc0 LB_f5
    s_lshl_b32 s40, s45, 7
    s_lshl_b32 s41, s46, 7
    v_lshrrev_b32 v4, 3, v2
    v_lshlrev_b32 v4, 5, v4
    v_lshl_add_u32 v4, v3, 3, v4
    v_add_u32 v4, s40, v4
    v_mul_u32_u24 v4, 3072, v4
    v_and_b32 v5, 7, v2
    v_lshl_add_u32 v4, v5, 4, v4
    v_add_u32 v4, s41, v4
    v_add_u32 v5, 196608, v4
    v_lshlrev_b32 v6, 2, v62
    global_load_dword v24, v6, s[4:5]
    global_load_dwordx4 v[128:131], v4, s[18:19] offset:0 nt
    global_load_dwordx4 v[132:135], v4, s[18:19] offset:3072 nt
    v_add_u32 v4, 6144, v4
    global_load_dwordx4 v[136:139], v4, s[18:19] offset:0 nt
    global_load_dwordx4 v[140:143], v4, s[18:19] offset:3072 nt
    v_add_u32 v4, 6144, v4
    global_load_dwordx4 v[144:147], v4, s[18:19] offset:0 nt
    global_load_dwordx4 v[148:151], v4, s[18:19] offset:3072 nt
    v_add_u32 v4, 6144, v4
    global_load_dwordx4 v[152:155], v4, s[18:19] offset:0 nt
    global_load_dwordx4 v[156:159], v4, s[18:19] offset:3072 nt
    global_load_dwordx4 v[160:163], v5, s[18:19] offset:0 nt
    global_load_dwordx4 v[164:167], v5, s[18:19] offset:3072 nt
    v_add_u32 v5, 6144, v5
    global_load_dwordx4 v[168:171], v5, s[18:19] offset:0 nt
    global_load_dwordx4 v[172:175], v5, s[18:19] offset:3072 nt
    v_add_u32 v5, 6144, v5
    global_load_dwordx4 v[176:179], v5, s[18:19] offset:0 nt
    global_load_dwordx4 v[180:183], v5, s[18:19] offset:3072 nt
    v_add_u32 v5, 6144, v5
    global_load_dwordx4 v[184:187], v5, s[18:19] offset:0 nt
    global_load_dwordx4 v[188:191], v5, s[18:19] offset:3072 nt
Lw_82:
    ds_read_b32 v8, v58 offset:0
    s_waitcnt lgkmcnt(0)
    v_cmp_gt_u32 vcc, 8, v8
    s_cbranch_vccz Lwd_83
    s_add_u32 s33, s33, 1
    s_cmp_gt_u32 s33, 200000
    s_cbranch_scc1 Lwd_83
    s_sleep 1
    s_branch Lw_82
Lwd_83:
    global_load_dwordx4 v[64:67], v10, s[20:21] offset:0 nt
    global_load_dwordx4 v[68:71], v10, s[20:21] offset:1280 nt
    global_load_dwordx4 v[72:75], v10, s[20:21] offset:2560 nt
    global_load_dwordx4 v[76:79], v10, s[20:21] offset:3840 nt
    v_add_u32 v10, 5120, v10
    global_load_dwordx4 v[80:83], v10, s[20:21] offset:0 nt
    global_load_dwordx4 v[84:87], v10, s[20:21] offset:1280 nt
    global_load_dwordx4 v[88:91], v10, s[20:21] offset:2560 nt
    global_load_dwordx4 v[92:95], v10, s[20:21] offset:3840 nt
    v_lshlrev_b32 v4, 2, v62
    v_add_u32 v4, 1081344, v4
    v_add_u32 v5, 2560, v4
    s_waitcnt vmcnt(8)
    v_perm_b32 v192, v132, v128, s34
    v_perm_b32 v193, v140, v136, s34
    v_perm_b32 v194, v148, v144, s34
    v_perm_b32 v195, v156, v152, s34
    v_perm_b32 v196, v132, v128, s35
    v_perm_b32 v197, v140, v136, s35
    v_perm_b32 v198, v148, v144, s35
    v_perm_b32 v199, v156, v152, s35
    v_perm_b32 v200, v133, v129, s34
    v_perm_b32 v201, v141, v137, s34
    v_perm_b32 v202, v149, v145, s34
    v_perm_b32 v203, v157, v153, s34
    v_perm_b32 v204, v133, v129, s35
    v_perm_b32 v205, v141, v137, s35
    v_perm_b32 v206, v149, v145, s35
    v_perm_b32 v207, v157, v153, s35
    v_perm_b32 v208, v134, v130, s34
    v_perm_b32 v209, v142, v138, s34
    v_perm_b32 v210, v150, v146, s34
    v_perm_b32 v211, v158, v154, s34
    v_perm_b32 v212, v134, v130, s35
    v_perm_b32 v213, v142, v138, s35
    v_perm_b32 v214, v150, v146, s35
    v_perm_b32 v215, v158, v154, s35
    v_perm_b32 v216, v135, v131, s34
    v_perm_b32 v217, v143, v139, s34
    v_perm_b32 v218, v151, v147, s34
    v_perm_b32 v219, v159, v155, s34
    v_perm_b32 v220, v135, v131, s35
    v_perm_b32 v221, v143, v139, s35
    v_perm_b32 v222, v151, v147, s35
    v_perm_b32 v223, v159, v155, s35
    v_perm_b32 v224, v164, v160, s34
    v_perm_b32 v225, v172, v168, s34
    v_perm_b32 v226, v180, v176, s34
    v_perm_b32 v227, v188, v184, s34
    v_perm_b32 v228, v164, v160, s35
    v_perm_b32 v229, v172, v168, s35
    v_perm_b32 v230, v180, v176, s35
    v_perm_b32 v231, v188, v184, s35
    v_perm_b32 v232, v165, v161, s34
    v_perm_b32 v233, v173, v169, s34
    v_perm_b32 v234, v181, v177, s34
    v_perm_b32 v235, v189, v185, s34
    v_perm_b32 v236, v165, v161, s35
    v_perm_b32 v237, v173, v169, s35
    v_perm_b32 v238, v181, v177, s35
    v_perm_b32 v239, v189, v185, s35
    v_perm_b32 v240, v166, v162, s34
    v_perm_b32 v241, v174, v170, s34
    v_perm_b32 v242, v182, v178, s34
    v_perm_b32 v243, v190, v186, s34
    v_perm_b32 v244, v166, v162, s35
    v_perm_b32 v245, v174, v170, s35
    v_perm_b32 v246, v182, v178, s35
    v_perm_b32 v247, v190, v186, s35
    v_perm_b32 v248, v167, v163, s34
    v_perm_b32 v249, v175, v171, s34
    v_perm_b32 v250, v183, v179, s34
    v_perm_b32 v251, v191, v187, s34
    v_perm_b32 v252, v167, v163, s35
    v_perm_b32 v253, v175, v171, s35
    v_perm_b32 v254, v183, v179, s35
    v_perm_b32 v255, v191, v187, s35
    s_waitcnt vmcnt(0)
    v_perm_b32 v96, v68, v64, s34
    v_perm_b32 v97, v76, v72, s34
    v_perm_b32 v98, v84, v80, s34
    v_perm_b32 v99, v92, v88, s34
    v_perm_b32 v100, v68, v64, s35
    v_perm_b32 v101, v76, v72, s35
    v_perm_b32 v102, v84, v80, s35
    v_perm_b32 v103, v92, v88, s35
    v_perm_b32 v104, v69, v65, s34
    v_perm_b32 v105, v77, v73, s34
    v_perm_b32 v106, v85, v81, s34
    v_perm_b32 v107, v93, v89, s34
    v_perm_b32 v108, v69, v65, s35
    v_perm_b32 v109, v77, v73, s35
    v_perm_b32 v110, v85, v81, s35
    v_perm_b32 v111, v93, v89, s35
    v_perm_b32 v112, v70, v66, s34
    v_perm_b32 v113, v78, v74, s34
    v_perm_b32 v114, v86, v82, s34
    v_perm_b32 v115, v94, v90, s34
    v_perm_b32 v116, v70, v66, s35
    v_perm_b32 v117, v78, v74, s35
    v_perm_b32 v118, v86, v82, s35
    v_perm_b32 v119, v94, v90, s35
    v_perm_b32 v120, v71, v67, s34
    v_perm_b32 v121, v79, v75, s34
    v_perm_b32 v122, v87, v83, s34
    v_perm_b32 v123, v95, v91, s34
    v_perm_b32 v124, v71, v67, s35
    v_perm_b32 v125, v79, v75, s35
    v_perm_b32 v126, v87, v83, s35
    v_perm_b32 v127, v95, v91, s35
    v_mov_b32 v58, v4
    v_mov_b32 v59, v5
    v_lshlrev_b32 v4, 3, v62
    v_add_u32 v8, 1048576, v4
    v_lshlrev_b32 v28, 16, v24
    v_and_b32 v29, 0xffff0000, v24
    v_add_u32 v9, 5120, v8
    v_add_u32 v10, 10240, v8
    v_add_u32 v11, 15360, v8
    s_lshl_b32 s40, s45, 3
    s_add_u32 s40, s40, 151552
    v_mov_b32 v13, s40
    s_lshl_b32 s40, s45, 8
    s_add_u32 s40, s40, 147456
    v_lshl_add_u32 v5, v1, 2, s40
    v_and_b32 v6, 1, v2
    v_lshlrev_b32 v6, 6, v6
    v_lshl_add_u32 v6, v3, 4, v6
    v_add_u32 v6, s40, v6
    s_lshl_b32 s40, s45, 8
    s_add_u32 s40, s40, 143360
    v_and_b32 v14, 7, v2
    v_lshlrev_b32 v14, 5, v14
    v_lshrrev_b32 v15, 3, v2
    v_lshl_add_u32 v14, v15, 4, v14
    v_add_u32 v14, s40, v14
Lp_84:
    global_load_dword v25, v58, s[30:31] sc1
    global_load_dword v26, v58, s[30:31] offset:1280 sc1
    global_load_dword v27, v59, s[30:31] sc1
    global_load_dword v38, v59, s[30:31] offset:1280 sc1
    global_load_dwordx2 v[40:41], v8, s[30:31] offset:0 sc1
    global_load_dwordx2 v[42:43], v8, s[30:31] offset:2560 sc1
    global_load_dwordx2 v[44:45], v9, s[30:31] offset:0 sc1
    global_load_dwordx2 v[46:47], v9, s[30:31] offset:2560 sc1
    global_load_dwordx2 v[48:49], v10, s[30:31] offset:0 sc1
    global_load_dwordx2 v[50:51], v10, s[30:31] offset:2560 sc1
    global_load_dwordx2 v[52:53], v11, s[30:31] offset:0 sc1
    global_load_dwordx2 v[54:55], v11, s[30:31] offset:2560 sc1
Lc_86:
    s_waitcnt vmcnt(0)
    v_max3_u32 v4, v25, v26, v27
    v_max3_u32 v4, v4, v38, v40
    v_max3_u32 v4, v4, v41, v42
    v_max3_u32 v4, v4, v43, v44
    v_max3_u32 v4, v4, v45, v46
    v_max3_u32 v4, v4, v47, v48
    v_max3_u32 v4, v4, v49, v50
    v_max3_u32 v4, v4, v51, v52
    v_max3_u32 v4, v4, v53, v54
    v_max_u32 v4, v4, v55
    v_cmp_eq_u32 vcc, -1, v4
    s_cbranch_vccz Ld_85
    s_add_u32 s33, s33, 1
    s_cmp_gt_u32 s33, 200000
    s_cbranch_scc1 Ld_85
    s_sleep 3
    s_branch Lp_84
Ld_85:
    s_setprio 3
    v_lshlrev_b32 v30, 16, v25
    v_and_b32 v31, 0xffff0000, v25
    v_add_f32 v40, v40, v42
    v_add_f32 v41, v41, v43
    v_add_f32 v44, v44, v46
    v_add_f32 v45, v45, v47
    v_add_f32 v48, v48, v50
    v_add_f32 v49, v49, v51
    v_add_f32 v52, v52, v54
    v_add_f32 v53, v53, v55
    v_add_f32 v40, v40, v44
    v_add_f32 v41, v41, v45
    v_add_f32 v48, v48, v52
    v_add_f32 v49, v49, v53
    v_add_f32 v40, v40, v48
    v_add_f32 v41, v41, v49
    v_cvt_pk_bf16_f32 v40, v40, v40
    v_and_b32 v40, 0xffff0000, v40
    v_cvt_pk_bf16_f32 v41, v41, v41
    v_and_b32 v41, 0xffff0000, v41
    v_mul_f32 v40, v30, v40
    v_mul_f32 v41, v31, v41
    v_cvt_pk_bf16_f32 v40, v40, v40
    v_and_b32 v40, 0xffff0000, v40
    v_cvt_pk_bf16_f32 v41, v41, v41
    v_and_b32 v41, 0xffff0000, v41
    v_add_f32 v40, v28, v40
    v_add_f32 v41, v29, v41
    v_cvt_pk_bf16_f32 v36, v40, v41
    v_lshlrev_b32 v40, 16, v36
    v_and_b32 v41, 0xffff0000, v36
    v_readfirstlane_b32 s42, v40
    s_nop 1
    v_subrev_f32 v44, s42, v40
    v_subrev_f32 v45, s42, v41
    v_add_f32 v42, v44, v45
    v_mul_f32 v43, v44, v44
    v_fmac_f32 v43, v45, v45
    v_add_f32_dpp v42, v42, v42 row_ror:8 row_mask:0xf bank_mask:0xf
    s_nop 0
    v_add_f32_dpp v43, v43, v43 row_ror:8 row_mask:0xf bank_mask:0xf
    v_add_f32_dpp v42, v42, v42 row_ror:4 row_mask:0xf bank_mask:0xf
    s_nop 0
    v_add_f32_dpp v43, v43, v43 row_ror:4 row_mask:0xf bank_mask:0xf
    v_add_f32_dpp v42, v42, v42 row_ror:2 row_mask:0xf bank_mask:0xf
    s_nop 0
    v_add_f32_dpp v43, v43, v43 row_ror:2 row_mask:0xf bank_mask:0xf
    v_add_f32_dpp v42, v42, v42 row_ror:1 row_mask:0xf bank_mask:0xf
    s_nop 0
    v_add_f32_dpp v43, v43, v43 row_ror:1 row_mask:0xf bank_mask:0xf
    s_nop 1
    v_permlane16_swap_b32 v42, v43
    v_add_f32 v42, v42, v43
    v_mov_b32 v43, v42
    s_nop 1
    v_permlane32_swap_b32 v42, v43
    v_add_f32 v42, v42, v43
    v_mov_b32 v43, v42
    s_nop 1
    v_permlane16_swap_b32 v42, v43
    v_mul_f32 v42, 0x3c000000, v42
    v_mul_f32 v44, 0x43000000, v42
    v_fma_f32 v43, -v44, v42, v43
    v_add_f32 v42, s42, v42
    ds_write_b64 v13, v[42:43]
    v_lshlrev_b32 v32, 16, v26
    v_and_b32 v33, 0xffff0000, v26
    v_lshlrev_b32 v34, 16, v27
    v_and_b32 v35, 0xffff0000, v27
    v_add_f32 v34, 1.0, v34
    v_add_f32 v35, 1.0, v35
    v_cvt_pk_bf16_f32 v34, v34, v35
    v_and_b32 v35, 0xffff0000, v34
    v_lshlrev_b32 v34, 16, v34
    s_branch LB_w1b
LB_f5:
    global_load_dwordx4 v[64:67], v10, s[20:21] offset:0 nt
    global_load_dwordx4 v[68:71], v10, s[20:21] offset:1280 nt
    global_load_dwordx4 v[72:75], v10, s[20:21] offset:2560 nt
    global_load_dwordx4 v[76:79], v10, s[20:21] offset:3840 nt
    v_add_u32 v10, 5120, v10
    global_load_dwordx4 v[80:83], v10, s[20:21] offset:0 nt
    global_load_dwordx4 v[84:87], v10, s[20:21] offset:1280 nt
    global_load_dwordx4 v[88:91], v10, s[20:21] offset:2560 nt
    global_load_dwordx4 v[92:95], v10, s[20:21] offset:3840 nt
    s_cmp_lt_u32 s3, 4
    s_cbranch_scc0 LB_f7
    s_lshl_b32 s40, s46, 6
    s_add_u32 s41, s3, 6
    s_lshl_b32 s41, s41, 7
    v_lshrrev_b32 v10, 3, v2
    v_lshlrev_b32 v10, 5, v10
    v_lshl_add_u32 v10, v3, 3, v10
    v_add_u32 v10, s40, v10
    v_mul_u32_u24 v10, 1280, v10
    v_and_b32 v11, 7, v2
    v_lshl_add_u32 v10, v11, 4, v10
    v_add_u32 v10, s41, v10
    global_load_dwordx4 v[128:131], v10, s[20:21] offset:0 nt
    global_load_dwordx4 v[132:135], v10, s[20:21] offset:1280 nt
    global_load_dwordx4 v[136:139], v10, s[20:21] offset:2560 nt
    global_load_dwordx4 v[140:143], v10, s[20:21] offset:3840 nt
    v_add_u32 v10, 5120, v10
    global_load_dwordx4 v[144:147], v10, s[20:21] offset:0 nt
    global_load_dwordx4 v[148:151], v10, s[20:21] offset:1280 nt
    global_load_dwordx4 v[152:155], v10, s[20:21] offset:2560 nt
    global_load_dwordx4 v[156:159], v10, s[20:21] offset:3840 nt
LB_f7:
    s_waitcnt vmcnt(0)
    v_perm_b32 v96, v68, v64, s34
    v_perm_b32 v97, v76, v72, s34
    v_perm_b32 v98, v84, v80, s34
    v_perm_b32 v99, v92, v88, s34
    v_perm_b32 v100, v68, v64, s35
    v_perm_b32 v101, v76, v72, s35
    v_perm_b32 v102, v84, v80, s35
    v_perm_b32 v103, v92, v88, s35
    v_perm_b32 v104, v69, v65, s34
    v_perm_b32 v105, v77, v73, s34
    v_perm_b32 v106, v85, v81, s34
    v_perm_b32 v107, v93, v89, s34
    v_perm_b32 v108, v69, v65, s35
    v_perm_b32 v109, v77, v73, s35
    v_perm_b32 v110, v85, v81, s35
    v_perm_b32 v111, v93, v89, s35
    v_perm_b32 v112, v70, v66, s34
    v_perm_b32 v113, v78, v74, s34
    v_perm_b32 v114, v86, v82, s34
    v_perm_b32 v115, v94, v90, s34
    v_perm_b32 v116, v70, v66, s35
    v_perm_b32 v117, v78, v74, s35
    v_perm_b32 v118, v86, v82, s35
    v_perm_b32 v119, v94, v90, s35
    v_perm_b32 v120, v71, v67, s34
    v_perm_b32 v121, v79, v75, s34
    v_perm_b32 v122, v87, v83, s34
    v_perm_b32 v123, v95, v91, s34
    v_perm_b32 v124, v71, v67, s35
    v_perm_b32 v125, v79, v75, s35
    v_perm_b32 v126, v87, v83, s35
    v_perm_b32 v127, v95, v91, s35
    v_perm_b32 v192, v132, v128, s34
    v_perm_b32 v193, v140, v136, s34
    v_perm_b32 v194, v148, v144, s34
    v_perm_b32 v195, v156, v152, s34
    v_perm_b32 v196, v132, v128, s35
    v_perm_b32 v197, v140, v136, s35
    v_perm_b32 v198, v148, v144, s35
    v_perm_b32 v199, v156, v152, s35
    v_perm_b32 v200, v133, v129, s34
    v_perm_b32 v201, v141, v137, s34
    v_perm_b32 v202, v149, v145, s34
    v_perm_b32 v203, v157, v153, s34
    v_perm_b32 v204, v133, v129, s35
    v_perm_b32 v205, v141, v137, s35
    v_perm_b32 v206, v149, v145, s35
    v_perm_b32 v207, v157, v153, s35
    v_perm_b32 v208, v134, v130, s34
    v_perm_b32 v209, v142, v138, s34
    v_perm_b32 v210, v150, v146, s34
    v_perm_b32 v211, v158, v154, s34
    v_perm_b32 v212, v134, v130, s35
    v_perm_b32 v213, v142, v138, s35
    v_perm_b32 v214, v150, v146, s35
    v_perm_b32 v215, v158, v154, s35
    v_perm_b32 v216, v135, v131, s34
    v_perm_b32 v217, v143, v139, s34
    v_perm_b32 v218, v151, v147, s34
    v_perm_b32 v219, v159, v155, s34
    v_perm_b32 v220, v135, v131, s35
    v_perm_b32 v221, v143, v139, s35
    v_perm_b32 v222, v151, v147, s35
    v_perm_b32 v223, v159, v155, s35
LB_w1b:
    v_mov_b32 v4, 151552
    s_waitcnt lgkmcnt(0)
    s_barrier
    s_setprio 3
    s_cmp_lt_u32 s45, 5
    s_cbranch_scc0 LB_w1c
    ds_read_b128 v[44:47], v4
    ds_read_b128 v[48:51], v4 offset:16
    ds_read_b64 v[52:53], v4 offset:32
    s_waitcnt lgkmcnt(0)
    v_add_f32 v54, v44, v46
    v_add_f32 v55, v48, v50
    v_add_f32 v56, v45, v47
    v_add_f32 v54, v54, v55
    v_add_f32 v57, v49, v51
    v_add_f32 v54, v54, v52
    v_add_f32 v55, v56, v57
    v_mul_f32 v54, 0x3e4ccccd, v54
    v_add_f32 v55, v55, v53
    v_sub_f32 v44, v44, v54
    v_sub_f32 v46, v46, v54
    v_sub_f32 v48, v48, v54
    v_sub_f32 v50, v50, v54
    v_sub_f32 v52, v52, v54
    v_mul_f32 v56, v44, v44
    v_mul_f32 v57, v46, v46
    v_fmac_f32 v56, v48, v48
    v_fmac_f32 v57, v50, v50
    v_fmac_f32 v56, v52, v52
    v_add_f32 v56, v56, v57
    v_fmac_f32 v55, 0x43000000, v56
    v_mul_f32 v55, 0x3acccccd, v55
    v_cvt_pk_bf16_f32 v54, v54, v54
    v_and_b32 v54, 0xffff0000, v54
    v_cvt_pk_bf16_f32 v55, v55, v55
    v_and_b32 v55, 0xffff0000, v55
    v_add_f32 v55, 0x3727c5ac, v55
    v_cvt_pk_bf16_f32 v55, v55, v55
    v_and_b32 v55, 0xffff0000, v55
    v_sqrt_f32 v55, v55
    s_nop 0
    v_cvt_pk_bf16_f32 v55, v55, v55
    v_and_b32 v55, 0xffff0000, v55
    v_rcp_f32 v56, v55
    s_nop 0
    v_fma_f32 v57, -v55, v56, 1.0
    v_fma_f32 v56, v57, v56, v56
    v_sub_f32 v44, v40, v54
    v_sub_f32 v45, v41, v54
    v_cvt_pk_bf16_f32 v44, v44, v44
    v_and_b32 v44, 0xffff0000, v44
    v_cvt_pk_bf16_f32 v45, v45, v45
    v_and_b32 v45, 0xffff0000, v45
    v_mul_f32 v42, v44, v56
    v_fma_f32 v57, -v55, v42, v44
    v_fma_f32 v42, v57, v56, v42
    v_mul_f32 v43, v45, v56
    v_fma_f32 v58, -v55, v43, v45
    v_fma_f32 v43, v58, v56, v43
    v_cvt_pk_bf16_f32 v42, v42, v42
    v_and_b32 v42, 0xffff0000, v42
    v_cvt_pk_bf16_f32 v43, v43, v43
    v_and_b32 v43, 0xffff0000, v43
    v_mul_f32 v42, v42, v34
    v_mul_f32 v43, v43, v35
    v_cvt_pk_bf16_f32 v42, v42, v42
    v_and_b32 v42, 0xffff0000, v42
    v_cvt_pk_bf16_f32 v43, v43, v43
    v_and_b32 v43, 0xffff0000, v43
    v_add_f32 v42, v42, v32
    v_add_f32 v43, v43, v33
    v_cvt_pk_bf16_f32 v42, v42, v43
    ds_write_b32 v5, v42
    s_waitcnt lgkmcnt(0)
    ds_read_b128 v[16:19], v6
    ds_read_b128 v[20:23], v6 offset:128
    s_waitcnt lgkmcnt(1)
    v_mfma_f32_16x16x32_bf16 v[128:131], v[16:19], v[192:195], 0
    v_mfma_f32_16x16x32_bf16 v[132:135], v[16:19], v[196:199], 0
    v_mfma_f32_16x16x32_bf16 v[136:139], v[16:19], v[200:203], 0
    v_mfma_f32_16x16x32_bf16 v[140:143], v[16:19], v[204:207], 0
    v_mfma_f32_16x16x32_bf16 v[144:147], v[16:19], v[208:211], 0
    v_mfma_f32_16x16x32_bf16 v[148:151], v[16:19], v[212:215], 0
    v_mfma_f32_16x16x32_bf16 v[152:155], v[16:19], v[216:219], 0
    v_mfma_f32_16x16x32_bf16 v[156:159], v[16:19], v[220:223], 0
    s_waitcnt lgkmcnt(0)
    v_mfma_f32_16x16x32_bf16 v[128:131], v[20:23], v[224:227], v[128:131]
    v_mfma_f32_16x16x32_bf16 v[132:135], v[20:23], v[228:231], v[132:135]
    v_mfma_f32_16x16x32_bf16 v[136:139], v[20:23], v[232:235], v[136:139]
    v_mfma_f32_16x16x32_bf16 v[140:143], v[20:23], v[236:239], v[140:143]
    v_mfma_f32_16x16x32_bf16 v[144:147], v[20:23], v[240:243], v[144:147]
    v_mfma_f32_16x16x32_bf16 v[148:151], v[20:23], v[244:247], v[148:151]
    v_mfma_f32_16x16x32_bf16 v[152:155], v[20:23], v[248:251], v[152:155]
    v_mfma_f32_16x16x32_bf16 v[156:159], v[20:23], v[252:255], v[156:159]
    s_nop 0
    v_add_f32_dpp v8, v129, v128 row_ror:8 row_mask:0xf bank_mask:0x3
    v_add_f32_dpp v9, v133, v132 row_ror:8 row_mask:0xf bank_mask:0x3
    v_add_f32_dpp v10, v137, v136 row_ror:8 row_mask:0xf bank_mask:0x3
    v_add_f32_dpp v11, v141, v140 row_ror:8 row_mask:0xf bank_mask:0x3
    v_add_f32_dpp v8, v144, v145 row_ror:8 row_mask:0xf bank_mask:0xc
    v_add_f32_dpp v9, v148, v149 row_ror:8 row_mask:0xf bank_mask:0xc
    v_add_f32_dpp v10, v152, v153 row_ror:8 row_mask:0xf bank_mask:0xc
    v_add_f32_dpp v11, v156, v157 row_ror:8 row_mask:0xf bank_mask:0xc
    s_mov_b32 exec_lo, 0xffff
    s_mov_b32 exec_hi, 0x0
    ds_write_b128 v14, v[8:11]
    s_mov_b64 exec, -1
LB_w1c:
    v_and_b32 v4, 31, v1
    v_lshlrev_b32 v5, 2, v4
    v_lshlrev_b32 v4, 3, v4
    v_add_u32 v4, 143360, v4
    s_lshl_b32 s40, s3, 7
    s_add_u32 s40, s40, 149504
    v_add_u32 v5, s40, v5
    v_and_b32 v6, 1, v2
    v_lshlrev_b32 v6, 6, v6
    v_lshl_add_u32 v6, v3, 4, v6
    v_add_u32 v6, s40, v6
    s_mul_i32 s40, s46, 2560
    s_lshl_b32 s41, s3, 8
    s_add_u32 s40, s40, s41
    s_add_u32 s40, s40, 1114112
    v_and_b32 v14, 7, v2
    v_lshlrev_b32 v14, 5, v14
    v_lshrrev_b32 v15, 3, v2
    v_lshl_add_u32 v14, v15, 4, v14
    v_add_u32 v14, s40, v14
    s_waitcnt lgkmcnt(0)
    s_barrier
    ds_read_b64 v[16:17], v4 offset:0
    ds_read_b64 v[18:19], v4 offset:256
    ds_read_b64 v[20:21], v4 offset:512
    ds_read_b64 v[22:23], v4 offset:768
    ds_read_b64 v[24:25], v4 offset:1024
    s_waitcnt lgkmcnt(0)
    v_add_f32 v16, v16, v18
    v_add_f32 v17, v17, v19
    v_add_f32 v20, v20, v22
    v_add_f32 v21, v21, v23
    v_add_f32 v16, v16, v20
    v_add_f32 v17, v17, v21
    v_add_f32 v16, v16, v24
    v_add_f32 v17, v17, v25
    v_max_f32 v16, 0, v16
    v_max_f32 v17, 0, v17
    v_cvt_pk_bf16_f32 v8, v16, v17
    ds_write_b32 v5, v8
    s_waitcnt lgkmcnt(0)
    ds_read_b128 v[16:19], v6
    s_waitcnt lgkmcnt(0)
    v_mfma_f32_16x16x32_bf16 v[64:67], v[16:19], v[96:99], 0
    v_mfma_f32_16x16x32_bf16 v[68:71], v[16:19], v[100:103], 0
    v_mfma_f32_16x16x32_bf16 v[72:75], v[16:19], v[104:107], 0
    v_mfma_f32_16x16x32_bf16 v[76:79], v[16:19], v[108:111], 0
    v_mfma_f32_16x16x32_bf16 v[80:83], v[16:19], v[112:115], 0
    v_mfma_f32_16x16x32_bf16 v[84:87], v[16:19], v[116:119], 0
    v_mfma_f32_16x16x32_bf16 v[88:91], v[16:19], v[120:123], 0
    v_mfma_f32_16x16x32_bf16 v[92:95], v[16:19], v[124:127], 0
    s_sub_u32 s40, s3, 2
    s_cmp_lt_u32 s40, 2
    s_cbranch_scc0 LB_y1
    v_mfma_f32_16x16x32_bf16 v[128:131], v[16:19], v[192:195], 0
    v_mfma_f32_16x16x32_bf16 v[132:135], v[16:19], v[196:199], 0
    v_mfma_f32_16x16x32_bf16 v[136:139], v[16:19], v[200:203], 0
    v_mfma_f32_16x16x32_bf16 v[140:143], v[16:19], v[204:207], 0
    v_mfma_f32_16x16x32_bf16 v[144:147], v[16:19], v[208:211], 0
    v_mfma_f32_16x16x32_bf16 v[148:151], v[16:19], v[212:215], 0
    v_mfma_f32_16x16x32_bf16 v[152:155], v[16:19], v[216:219], 0
    v_mfma_f32_16x16x32_bf16 v[156:159], v[16:19], v[220:223], 0
LB_y1:
    v_add_f32_dpp v8, v65, v64 row_ror:8 row_mask:0xf bank_mask:0x3
    v_add_f32_dpp v9, v69, v68 row_ror:8 row_mask:0xf bank_mask:0x3
    v_add_f32_dpp v10, v73, v72 row_ror:8 row_mask:0xf bank_mask:0x3
    v_add_f32_dpp v11, v77, v76 row_ror:8 row_mask:0xf bank_mask:0x3
    v_add_f32_dpp v8, v80, v81 row_ror:8 row_mask:0xf bank_mask:0xc
    v_add_f32_dpp v9, v84, v85 row_ror:8 row_mask:0xf bank_mask:0xc
    v_add_f32_dpp v10, v88, v89 row_ror:8 row_mask:0xf bank_mask:0xc
    v_add_f32_dpp v11, v92, v93 row_ror:8 row_mask:0xf bank_mask:0xc
    s_mov_b32 exec_lo, 0xffff
    s_mov_b32 exec_hi, 0x0
    global_store_dwordx4 v14, v[8:11], s[30:31] sc1
    s_mov_b64 exec, -1
    s_cbranch_scc0 LB_y2
    v_add_f32_dpp v20, v129, v128 row_ror:8 row_mask:0xf bank_mask:0x3
    v_add_f32_dpp v21, v133, v132 row_ror:8 row_mask:0xf bank_mask:0x3
    v_add_f32_dpp v22, v137, v136 row_ror:8 row_mask:0xf bank_mask:0x3
    v_add_f32_dpp v23, v141, v140 row_ror:8 row_mask:0xf bank_mask:0x3
    v_add_f32_dpp v20, v144, v145 row_ror:8 row_mask:0xf bank_mask:0xc
    v_add_f32_dpp v21, v148, v149 row_ror:8 row_mask:0xf bank_mask:0xc
    v_add_f32_dpp v22, v152, v153 row_ror:8 row_mask:0xf bank_mask:0xc
    v_add_f32_dpp v23, v156, v157 row_ror:8 row_mask:0xf bank_mask:0xc
    s_mov_b32 exec_lo, 0xffff
    s_mov_b32 exec_hi, 0x0
    global_store_dwordx4 v14, v[20:23], s[30:31] offset:1536 sc1
    s_mov_b64 exec, -1
LB_y2:
    s_lshr_b32 s40, s46, 2
    s_cmp_eq_u32 s40, s45
    s_cbranch_scc0 Lfin
    s_cmp_lt_u32 s45, 5
    s_cbranch_scc0 Lfin
    s_and_b32 s40, s46, 3
    s_lshl_b32 s40, s40, 4
    s_mov_b64 s[42:43], 0xffff
    s_lshl_b64 exec, s[42:43], s40
    v_lshlrev_b32 v4, 3, v62
    v_add_u32 v4, 1114112, v4
    v_add_u32 v17, 5120, v4
    v_add_u32 v18, 10240, v4
    v_add_u32 v19, 15360, v4
    v_add_u32 v20, 20480, v4
    v_add_u32 v21, 25600, v4
    v_add_u32 v22, 30720, v4
    v_add_u32 v23, 35840, v4
    v_add_u32 v24, 40960, v4
    v_add_u32 v25, 46080, v4
    v_add_u32 v26, 51200, v4
    v_add_u32 v27, 56320, v4
    v_mov_b32 v16, v4
    v_lshlrev_b32 v5, 2, v62
    v_lshlrev_b32 v30, 16, v38
    v_and_b32 v31, 0xffff0000, v38
    s_sleep 12
Lp_87:
    global_load_dwordx2 v[64:65], v16, s[30:31] offset:0 sc1
    global_load_dwordx2 v[66:67], v16, s[30:31] offset:2560 sc1
    global_load_dwordx2 v[68:69], v17, s[30:31] offset:0 sc1
    global_load_dwordx2 v[70:71], v17, s[30:31] offset:2560 sc1
    global_load_dwordx2 v[72:73], v18, s[30:31] offset:0 sc1
    global_load_dwordx2 v[74:75], v18, s[30:31] offset:2560 sc1
    global_load_dwordx2 v[76:77], v19, s[30:31] offset:0 sc1
    global_load_dwordx2 v[78:79], v19, s[30:31] offset:2560 sc1
    global_load_dwordx2 v[80:81], v20, s[30:31] offset:0 sc1
    global_load_dwordx2 v[82:83], v20, s[30:31] offset:2560 sc1
    global_load_dwordx2 v[84:85], v21, s[30:31] offset:0 sc1
    global_load_dwordx2 v[86:87], v21, s[30:31] offset:2560 sc1
    global_load_dwordx2 v[88:89], v22, s[30:31] offset:0 sc1
    global_load_dwordx2 v[90:91], v22, s[30:31] offset:2560 sc1
    global_load_dwordx2 v[92:93], v23, s[30:31] offset:0 sc1
    global_load_dwordx2 v[94:95], v23, s[30:31] offset:2560 sc1
    global_load_dwordx2 v[96:97], v24, s[30:31] offset:0 sc1
    global_load_dwordx2 v[98:99], v24, s[30:31] offset:2560 sc1
    global_load_dwordx2 v[100:101], v25, s[30:31] offset:0 sc1
    global_load_dwordx2 v[102:103], v25, s[30:31] offset:2560 sc1
    global_load_dwordx2 v[104:105], v26, s[30:31] offset:0 sc1
    global_load_dwordx2 v[106:107], v26, s[30:31] offset:2560 sc1
    global_load_dwordx2 v[108:109], v27, s[30:31] offset:0 sc1
    global_load_dwordx2 v[110:111], v27, s[30:31] offset:2560 sc1
Lc_89:
    s_waitcnt vmcnt(0)
    v_max3_u32 v4, v64, v65, v66
    v_max3_u32 v4, v4, v67, v68
    v_max3_u32 v4, v4, v69, v70
    v_max3_u32 v4, v4, v71, v72
    v_max3_u32 v4, v4, v73, v74
    v_max3_u32 v4, v4, v75, v76
    v_max3_u32 v4, v4, v77, v78
    v_max3_u32 v4, v4, v79, v80
    v_max3_u32 v4, v4, v81, v82
    v_max3_u32 v4, v4, v83, v84
    v_max3_u32 v4, v4, v85, v86
    v_max3_u32 v4, v4, v87, v88
    v_max3_u32 v4, v4, v89, v90
    v_max3_u32 v4, v4, v91, v92
    v_max3_u32 v4, v4, v93, v94
    v_max3_u32 v4, v4, v95, v96
    v_max3_u32 v4, v4, v97, v98
    v_max3_u32 v4, v4, v99, v100
    v_max3_u32 v4, v4, v101, v102
    v_max3_u32 v4, v4, v103, v104
    v_max3_u32 v4, v4, v105, v106
    v_max3_u32 v4, v4, v107, v108
    v_max3_u32 v4, v4, v109, v110
    v_max_u32 v4, v4, v111
    v_cmp_eq_u32 vcc, -1, v4
    s_cbranch_vccz Ld_88
    s_add_u32 s33, s33, 1
    s_cmp_gt_u32 s33, 200000
    s_cbranch_scc1 Ld_88
    s_sleep 2
    s_branch Lp_87
Ld_88:
    v_add_f32 v64, v64, v66
    v_add_f32 v65, v65, v67
    v_add_f32 v68, v68, v70
    v_add_f32 v69, v69, v71
    v_add_f32 v72, v72, v74
    v_add_f32 v73, v73, v75
    v_add_f32 v76, v76, v78
    v_add_f32 v77, v77, v79
    v_add_f32 v80, v80, v82
    v_add_f32 v81, v81, v83
    v_add_f32 v84, v84, v86
    v_add_f32 v85, v85, v87
    v_add_f32 v88, v88, v90
    v_add_f32 v89, v89, v91
    v_add_f32 v92, v92, v94
    v_add_f32 v93, v93, v95
    v_add_f32 v96, v96, v98
    v_add_f32 v97, v97, v99
    v_add_f32 v100, v100, v102
    v_add_f32 v101, v101, v103
    v_add_f32 v104, v104, v106
    v_add_f32 v105, v105, v107
    v_add_f32 v108, v108, v110
    v_add_f32 v109, v109, v111
    v_add_f32 v64, v64, v68
    v_add_f32 v65, v65, v69
    v_add_f32 v72, v72, v76
    v_add_f32 v73, v73, v77
    v_add_f32 v80, v80, v84
    v_add_f32 v81, v81, v85
    v_add_f32 v88, v88, v92
    v_add_f32 v89, v89, v93
    v_add_f32 v96, v96, v100
    v_add_f32 v97, v97, v101
    v_add_f32 v104, v104, v108
    v_add_f32 v105, v105, v109
    v_add_f32 v64, v64, v72
    v_add_f32 v65, v65, v73
    v_add_f32 v80, v80, v88
    v_add_f32 v81, v81, v89
    v_add_f32 v96, v96, v104
    v_add_f32 v97, v97, v105
    v_add_f32 v64, v64, v80
    v_add_f32 v65, v65, v81
    v_add_f32 v64, v64, v96
    v_add_f32 v65, v65, v97
    v_cvt_pk_bf16_f32 v64, v64, v64
    v_and_b32 v64, 0xffff0000, v64
    v_cvt_pk_bf16_f32 v65, v65, v65
    v_and_b32 v65, 0xffff0000, v65
    v_mul_f32 v64, v30, v64
    v_mul_f32 v65, v31, v65
    v_cvt_pk_bf16_f32 v64, v64, v64
    v_and_b32 v64, 0xffff0000, v64
    v_cvt_pk_bf16_f32 v65, v65, v65
    v_and_b32 v65, 0xffff0000, v65
    v_add_f32 v64, v40, v64
    v_add_f32 v65, v41, v65
    v_cvt_pk_bf16_f32 v64, v64, v65
    global_store_dword v5, v64, s[26:27]
    s_mov_b64 exec, -1
    s_branch Lfin
LB_mr:
    s_cmp_lt_u32 s54, 124
    s_cbranch_scc0 Lfin
    s_sub_u32 s46, s54, 104
    s_add_u32 s45, s3, 3
    s_and_b32 s45, s45, 7
    s_cmp_lt_u32 s45, 5
    s_cbranch_scc0 LB_mrb
    s_lshl_b32 s40, s45, 7
    v_lshl_add_u32 v4, v3, 3, s40
    v_lshlrev_b32 v6, 1, v4
    v_add_u32 v6, 147456, v6
    v_mul_u32_u24 v4, 7680, v4
    v_lshl_add_u32 v4, v2, 4, v4
    s_lshl_b32 s40, s46, 8
    s_add_u32 s40, s40, 2560
    v_add_u32 v4, s40, v4
    s_lshl_b32 s40, s45, 8
    v_lshl_add_u32 v7, v1, 2, s40
    global_load_dword v16, v7, s[22:23]
    v_add_u32 v7, 147456, v7
    global_load_dwordx4 v[64:67], v4, s[24:25] offset:0 nt
    v_add_u32 v4, 7680, v4
    global_load_dwordx4 v[68:71], v4, s[24:25] offset:0 nt
    v_add_u32 v4, 7680, v4
    global_load_dwordx4 v[72:75], v4, s[24:25] offset:0 nt
    v_add_u32 v4, 7680, v4
    global_load_dwordx4 v[76:79], v4, s[24:25] offset:0 nt
    v_add_u32 v4, 7680, v4
    global_load_dwordx4 v[80:83], v4, s[24:25] offset:0 nt
    v_add_u32 v4, 7680, v4
    global_load_dwordx4 v[84:87], v4, s[24:25] offset:0 nt
    v_add_u32 v4, 7680, v4
    global_load_dwordx4 v[88:91], v4, s[24:25] offset:0 nt
    v_add_u32 v4, 7680, v4
    global_load_dwordx4 v[92:95], v4, s[24:25] offset:0 nt
    v_add_u32 v4, 192000, v4
    global_load_dwordx4 v[96:99], v4, s[24:25] offset:0 nt
    v_add_u32 v4, 7680, v4
    global_load_dwordx4 v[100:103], v4, s[24:25] offset:0 nt
    v_add_u32 v4, 7680, v4
    global_load_dwordx4 v[104:107], v4, s[24:25] offset:0 nt
    v_add_u32 v4, 7680, v4
    global_load_dwordx4 v[108:111], v4, s[24:25] offset:0 nt
    v_add_u32 v4, 7680, v4
    global_load_dwordx4 v[112:115], v4, s[24:25] offset:0 nt
    v_add_u32 v4, 7680, v4
    global_load_dwordx4 v[116:119], v4, s[24:25] offset:0 nt
    v_add_u32 v4, 7680, v4
    global_load_dwordx4 v[120:123], v4, s[24:25] offset:0 nt
    v_add_u32 v4, 7680, v4
    global_load_dwordx4 v[124:127], v4, s[24:25] offset:0 nt
    v_add_u32 v4, 192000, v4
Lw_90:
    ds_read_b32 v8, v58 offset:0
    s_waitcnt lgkmcnt(0)
    v_cmp_gt_u32 vcc, 8, v8
    s_cbranch_vccz Lwd_91
    s_add_u32 s33, s33, 1
    s_cmp_gt_u32 s33, 200000
    s_cbranch_scc1 Lwd_91
    s_sleep 1
    s_branch Lw_90
Lwd_91:
    global_load_dwordx4 v[128:131], v4, s[24:25] offset:0 nt
    v_add_u32 v4, 7680, v4
    global_load_dwordx4 v[132:135], v4, s[24:25] offset:0 nt
    v_add_u32 v4, 7680, v4
    global_load_dwordx4 v[136:139], v4, s[24:25] offset:0 nt
    v_add_u32 v4, 7680, v4
    global_load_dwordx4 v[140:143], v4, s[24:25] offset:0 nt
    v_add_u32 v4, 7680, v4
    global_load_dwordx4 v[144:147], v4, s[24:25] offset:0 nt
    v_add_u32 v4, 7680, v4
    global_load_dwordx4 v[148:151], v4, s[24:25] offset:0 nt
    v_add_u32 v4, 7680, v4
    global_load_dwordx4 v[152:155], v4, s[24:25] offset:0 nt
    v_add_u32 v4, 7680, v4
    global_load_dwordx4 v[156:159], v4, s[24:25] offset:0 nt
    v_add_u32 v4, 192000, v4
    global_load_dwordx4 v[160:163], v4, s[24:25] offset:0 nt
    v_add_u32 v4, 7680, v4
    global_load_dwordx4 v[164:167], v4, s[24:25] offset:0 nt
    v_add_u32 v4, 7680, v4
    global_load_dwordx4 v[168:171], v4, s[24:25] offset:0 nt
    v_add_u32 v4, 7680, v4
    global_load_dwordx4 v[172:175], v4, s[24:25] offset:0 nt
    v_add_u32 v4, 7680, v4
    global_load_dwordx4 v[176:179], v4, s[24:25] offset:0 nt
    v_add_u32 v4, 7680, v4
    global_load_dwordx4 v[180:183], v4, s[24:25] offset:0 nt
    v_add_u32 v4, 7680, v4
    global_load_dwordx4 v[184:187], v4, s[24:25] offset:0 nt
    v_add_u32 v4, 7680, v4
    global_load_dwordx4 v[188:191], v4, s[24:25] offset:0 nt
    s_waitcnt vmcnt(32)
    v_lshlrev_b32 v32, 16, v16
    v_and_b32 v33, 0xffff0000, v16
    v_mul_f32 v8, s56, v32
    v_fma_f32 v9, v32, s56, -v8
    v_fma_f32 v9, v32, s57, v9
    v_exp_f32 v8, -v8
    v_mul_f32 v9, s58, v9
    v_fma_f32 v8, -v8, v9, v8
    v_min_f32 v8, 0x7f000000, v8
    v_add_f32 v8, 1.0, v8
    v_rcp_f32 v9, v8
    s_nop 0
    v_fma_f32 v10, -v8, v9, 1.0
    v_fma_f32 v9, v10, v9, v9
    v_mul_f32 v11, v32, v9
    v_fma_f32 v10, -v8, v11, v32
    v_fma_f32 v11, v10, v9, v11
    v_cvt_pk_bf16_f32 v32, v11, v11
    v_and_b32 v32, 0xffff0000, v32
    v_mul_f32 v8, s56, v33
    v_fma_f32 v9, v33, s56, -v8
    v_fma_f32 v9, v33, s57, v9
    v_exp_f32 v8, -v8
    v_mul_f32 v9, s58, v9
    v_fma_f32 v8, -v8, v9, v8
    v_min_f32 v8, 0x7f000000, v8
    v_add_f32 v8, 1.0, v8
    v_rcp_f32 v9, v8
    s_nop 0
    v_fma_f32 v10, -v8, v9, 1.0
    v_fma_f32 v9, v10, v9, v9
    v_mul_f32 v11, v33, v9
    v_fma_f32 v10, -v8, v11, v33
    v_fma_f32 v11, v10, v9, v11
    v_cvt_pk_bf16_f32 v33, v11, v11
    v_and_b32 v33, 0xffff0000, v33
    v_perm_b32 v16, v33, v32, s35
    ds_write_b32 v7, v16
    s_waitcnt lgkmcnt(0)
    ds_read_b128 v[16:19], v6 offset:0
    ds_read_b128 v[20:23], v6 offset:64
    ds_read_b128 v[24:27], v6 offset:128
    ds_read_b128 v[28:31], v6 offset:192
    s_waitcnt lgkmcnt(0)
    v_cmp_eq_u32 s[42:43], 1, v3
    v_lshlrev_b32 v4, 5, v2
    v_lshl_add_u32 v4, v3, 4, v4
    s_lshl_b32 s40, s45, 9
    s_add_u32 s40, s40, 143360
    v_add_u32 v4, s40, v4
    s_waitcnt vmcnt(24)
    v_perm_b32 v192, v68, v64, s34
    v_perm_b32 v193, v76, v72, s34
    v_perm_b32 v194, v84, v80, s34
    v_perm_b32 v195, v92, v88, s34
    v_perm_b32 v196, v68, v64, s35
    v_perm_b32 v197, v76, v72, s35
    v_perm_b32 v198, v84, v80, s35
    v_perm_b32 v199, v92, v88, s35
    v_perm_b32 v200, v69, v65, s34
    v_perm_b32 v201, v77, v73, s34
    v_perm_b32 v202, v85, v81, s34
    v_perm_b32 v203, v93, v89, s34
    v_perm_b32 v204, v69, v65, s35
    v_perm_b32 v205, v77, v73, s35
    v_perm_b32 v206, v85, v81, s35
    v_perm_b32 v207, v93, v89, s35
    v_perm_b32 v208, v70, v66, s34
    v_perm_b32 v209, v78, v74, s34
    v_perm_b32 v210, v86, v82, s34
    v_perm_b32 v211, v94, v90, s34
    v_perm_b32 v212, v70, v66, s35
    v_perm_b32 v213, v78, v74, s35
    v_perm_b32 v214, v86, v82, s35
    v_perm_b32 v215, v94, v90, s35
    v_perm_b32 v216, v71, v67, s34
    v_perm_b32 v217, v79, v75, s34
    v_perm_b32 v218, v87, v83, s34
    v_perm_b32 v219, v95, v91, s34
    v_perm_b32 v220, v71, v67, s35
    v_perm_b32 v221, v79, v75, s35
    v_perm_b32 v222, v87, v83, s35
    v_perm_b32 v223, v95, v91, s35
    v_mfma_f32_16x16x32_bf16 v[224:227], v[16:19], v[192:195], 0
    v_mfma_f32_16x16x32_bf16 v[228:231], v[16:19], v[196:199], 0
    v_mfma_f32_16x16x32_bf16 v[232:235], v[16:19], v[200:203], 0
    v_mfma_f32_16x16x32_bf16 v[236:239], v[16:19], v[204:207], 0
    v_mfma_f32_16x16x32_bf16 v[240:243], v[16:19], v[208:211], 0
    v_mfma_f32_16x16x32_bf16 v[244:247], v[16:19], v[212:215], 0
    v_mfma_f32_16x16x32_bf16 v[248:251], v[16:19], v[216:219], 0
    v_mfma_f32_16x16x32_bf16 v[252:255], v[16:19], v[220:223], 0
    s_waitcnt vmcnt(16)
    v_perm_b32 v192, v100, v96, s34
    v_perm_b32 v193, v108, v104, s34
    v_perm_b32 v194, v116, v112, s34
    v_perm_b32 v195, v124, v120, s34
    v_perm_b32 v196, v100, v96, s35
    v_perm_b32 v197, v108, v104, s35
    v_perm_b32 v198, v116, v112, s35
    v_perm_b32 v199, v124, v120, s35
    v_perm_b32 v200, v101, v97, s34
    v_perm_b32 v201, v109, v105, s34
    v_perm_b32 v202, v117, v113, s34
    v_perm_b32 v203, v125, v121, s34
    v_perm_b32 v204, v101, v97, s35
    v_perm_b32 v205, v109, v105, s35
    v_perm_b32 v206, v117, v113, s35
    v_perm_b32 v207, v125, v121, s35
    v_perm_b32 v208, v102, v98, s34
    v_perm_b32 v209, v110, v106, s34
    v_perm_b32 v210, v118, v114, s34
    v_perm_b32 v211, v126, v122, s34
    v_perm_b32 v212, v102, v98, s35
    v_perm_b32 v213, v110, v106, s35
    v_perm_b32 v214, v118, v114, s35
    v_perm_b32 v215, v126, v122, s35
    v_perm_b32 v216, v103, v99, s34
    v_perm_b32 v217, v111, v107, s34
    v_perm_b32 v218, v119, v115, s34
    v_perm_b32 v219, v127, v123, s34
    v_perm_b32 v220, v103, v99, s35
    v_perm_b32 v221, v111, v107, s35
    v_perm_b32 v222, v119, v115, s35
    v_perm_b32 v223, v127, v123, s35
    v_mfma_f32_16x16x32_bf16 v[224:227], v[20:23], v[192:195], v[224:227]
    v_mfma_f32_16x16x32_bf16 v[228:231], v[20:23], v[196:199], v[228:231]
    v_mfma_f32_16x16x32_bf16 v[232:235], v[20:23], v[200:203], v[232:235]
    v_mfma_f32_16x16x32_bf16 v[236:239], v[20:23], v[204:207], v[236:239]
    v_mfma_f32_16x16x32_bf16 v[240:243], v[20:23], v[208:211], v[240:243]
    v_mfma_f32_16x16x32_bf16 v[244:247], v[20:23], v[212:215], v[244:247]
    v_mfma_f32_16x16x32_bf16 v[248:251], v[20:23], v[216:219], v[248:251]
    v_mfma_f32_16x16x32_bf16 v[252:255], v[20:23], v[220:223], v[252:255]
    s_waitcnt vmcnt(8)
    v_perm_b32 v192, v132, v128, s34
    v_perm_b32 v193, v140, v136, s34
    v_perm_b32 v194, v148, v144, s34
    v_perm_b32 v195, v156, v152, s34
    v_perm_b32 v196, v132, v128, s35
    v_perm_b32 v197, v140, v136, s35
    v_perm_b32 v198, v148, v144, s35
    v_perm_b32 v199, v156, v152, s35
    v_perm_b32 v200, v133, v129, s34
    v_perm_b32 v201, v141, v137, s34
    v_perm_b32 v202, v149, v145, s34
    v_perm_b32 v203, v157, v153, s34
    v_perm_b32 v204, v133, v129, s35
    v_perm_b32 v205, v141, v137, s35
    v_perm_b32 v206, v149, v145, s35
    v_perm_b32 v207, v157, v153, s35
    v_perm_b32 v208, v134, v130, s34
    v_perm_b32 v209, v142, v138, s34
    v_perm_b32 v210, v150, v146, s34
    v_perm_b32 v211, v158, v154, s34
    v_perm_b32 v212, v134, v130, s35
    v_perm_b32 v213, v142, v138, s35
    v_perm_b32 v214, v150, v146, s35
    v_perm_b32 v215, v158, v154, s35
    v_perm_b32 v216, v135, v131, s34
    v_perm_b32 v217, v143, v139, s34
    v_perm_b32 v218, v151, v147, s34
    v_perm_b32 v219, v159, v155, s34
    v_perm_b32 v220, v135, v131, s35
    v_perm_b32 v221, v143, v139, s35
    v_perm_b32 v222, v151, v147, s35
    v_perm_b32 v223, v159, v155, s35
    v_mfma_f32_16x16x32_bf16 v[224:227], v[24:27], v[192:195], v[224:227]
    v_mfma_f32_16x16x32_bf16 v[228:231], v[24:27], v[196:199], v[228:231]
    v_mfma_f32_16x16x32_bf16 v[232:235], v[24:27], v[200:203], v[232:235]
    v_mfma_f32_16x16x32_bf16 v[236:239], v[24:27], v[204:207], v[236:239]
    v_mfma_f32_16x16x32_bf16 v[240:243], v[24:27], v[208:211], v[240:243]
    v_mfma_f32_16x16x32_bf16 v[244:247], v[24:27], v[212:215], v[244:247]
    v_mfma_f32_16x16x32_bf16 v[248:251], v[24:27], v[216:219], v[248:251]
    v_mfma_f32_16x16x32_bf16 v[252:255], v[24:27], v[220:223], v[252:255]
    s_waitcnt vmcnt(0)
    v_perm_b32 v192, v164, v160, s34
    v_perm_b32 v193, v172, v168, s34
    v_perm_b32 v194, v180, v176, s34
    v_perm_b32 v195, v188, v184, s34
    v_perm_b32 v196, v164, v160, s35
    v_perm_b32 v197, v172, v168, s35
    v_perm_b32 v198, v180, v176, s35
    v_perm_b32 v199, v188, v184, s35
    v_perm_b32 v200, v165, v161, s34
    v_perm_b32 v201, v173, v169, s34
    v_perm_b32 v202, v181, v177, s34
    v_perm_b32 v203, v189, v185, s34
    v_perm_b32 v204, v165, v161, s35
    v_perm_b32 v205, v173, v169, s35
    v_perm_b32 v206, v181, v177, s35
    v_perm_b32 v207, v189, v185, s35
    v_perm_b32 v208, v166, v162, s34
    v_perm_b32 v209, v174, v170, s34
    v_perm_b32 v210, v182, v178, s34
    v_perm_b32 v211, v190, v186, s34
    v_perm_b32 v212, v166, v162, s35
    v_perm_b32 v213, v174, v170, s35
    v_perm_b32 v214, v182, v178, s35
    v_perm_b32 v215, v190, v186, s35
    v_perm_b32 v216, v167, v163, s34
    v_perm_b32 v217, v175, v171, s34
    v_perm_b32 v218, v183, v179, s34
    v_perm_b32 v219, v191, v187, s34
    v_perm_b32 v220, v167, v163, s35
    v_perm_b32 v221, v175, v171, s35
    v_perm_b32 v222, v183, v179, s35
    v_perm_b32 v223, v191, v187, s35
    v_mfma_f32_16x16x32_bf16 v[224:227], v[28:31], v[192:195], v[224:227]
    v_mfma_f32_16x16x32_bf16 v[228:231], v[28:31], v[196:199], v[228:231]
    v_mfma_f32_16x16x32_bf16 v[232:235], v[28:31], v[200:203], v[232:235]
    v_mfma_f32_16x16x32_bf16 v[236:239], v[28:31], v[204:207], v[236:239]
    v_mfma_f32_16x16x32_bf16 v[240:243], v[28:31], v[208:211], v[240:243]
    v_mfma_f32_16x16x32_bf16 v[244:247], v[28:31], v[212:215], v[244:247]
    v_mfma_f32_16x16x32_bf16 v[248:251], v[28:31], v[216:219], v[248:251]
    v_mfma_f32_16x16x32_bf16 v[252:255], v[28:31], v[220:223], v[252:255]
    s_nop 4
    v_cndmask_b32 v8, v224, v240, s[42:43]
    v_cndmask_b32 v9, v228, v244, s[42:43]
    v_cndmask_b32 v10, v232, v248, s[42:43]
    v_cndmask_b32 v11, v236, v252, s[42:43]
    s_mov_b32 exec_lo, 0xffffffff
    s_mov_b32 exec_hi, 0x0
    ds_write_b128 v4, v[8:11]
    s_mov_b64 exec, -1
LB_mrb:
    s_waitcnt lgkmcnt(0)
    s_barrier
    s_cmp_eq_u32 s3, 2
    s_cbranch_scc0 Lfin
    v_lshlrev_b32 v4, 3, v1
    v_add_u32 v4, 143360, v4
    ds_read_b64 v[16:17], v4 offset:0
    ds_read_b64 v[18:19], v4 offset:512
    ds_read_b64 v[20:21], v4 offset:1024
    ds_read_b64 v[22:23], v4 offset:1536
    ds_read_b64 v[24:25], v4 offset:2048
    s_lshl_b32 s40, s46, 8
    s_add_u32 s40, s40, 1081344
    v_lshl_add_u32 v4, v1, 2, s40
    s_waitcnt lgkmcnt(0)
    v_add_f32 v16, v16, v18
    v_add_f32 v17, v17, v19
    v_add_f32 v20, v20, v22
    v_add_f32 v21, v21, v23
    v_add_f32 v16, v16, v20
    v_add_f32 v17, v17, v21
    v_add_f32 v16, v16, v24
    v_add_f32 v17, v17, v25
    v_cvt_pk_bf16_f32 v8, v16, v17
    v_min_u32 v8, -2, v8
    s_nop 1
    v_mov_b32_dpp v9, v8 quad_perm:[1,1,1,1] row_mask:0xf bank_mask:0xf
    v_mov_b32_dpp v10, v8 quad_perm:[2,2,2,2] row_mask:0xf bank_mask:0xf
    v_mov_b32_dpp v11, v8 quad_perm:[3,3,3,3] row_mask:0xf bank_mask:0xf
    s_mov_b32 exec_lo, 0x11111111
    s_mov_b32 exec_hi, 0x11111111
    global_store_dwordx4 v4, v[8:11], s[30:31] sc1
    s_mov_b64 exec, -1
    s_branch Lfin
Lfin:
Lend:
    s_endpgm
Lcode_end:
.section .rodata,"a"
.p2align 6
.amdhsa_kernel adaLN_cond__compressed_kv_cla__dense_activation_relu__decode_kernel
  .amdhsa_next_free_vgpr 256
  .amdhsa_next_free_sgpr 102
  .amdhsa_accum_offset 256
  .amdhsa_group_segment_fixed_size 0
  .amdhsa_kernarg_size 112
  .amdhsa_user_sgpr_count 2
  .amdhsa_user_sgpr_kernarg_segment_ptr 1
  .amdhsa_system_sgpr_workgroup_id_x 1
  .amdhsa_float_denorm_mode_32 3
.end_amdhsa_kernel
```
